```python
import torch

def _softmax(x, axis=-1):
    return torch.softmax(x, dim=axis)
def _gelu(x):
    return torch.nn.functional.gelu(x, approximate="tanh")
def _silu(x):
    return torch.nn.functional.silu(x)
def _sigmoid(x):
    return torch.sigmoid(x)
def _layernorm(x, axis=-1, eps=1e-5):
    m = x.mean(dim=axis, keepdim=True)
    v = x.var(dim=axis, keepdim=True, unbiased=False)
    return (x - m) / torch.sqrt(v + eps)
def _scatter_add(tgt, idx, src, axis=0):
    return tgt.clone().index_add_(axis, idx, src)
def _segment_sum(src, seg, n):
    out = torch.zeros((n,) + src.shape[1:], dtype=src.dtype)
    return out.index_add_(0, seg, src)
def _pad(x, pw):
    flat = tuple(v for pair in reversed(pw) for v in pair)
    return torch.nn.functional.pad(x, flat)

kernel_name = 'sequential_preLN__compressed_kv_cla__dense_activation_squared_relu__decode'

def setup_inputs():

    _w = (lambda a: (lambda t: t.to(torch.bfloat16) if t.is_floating_point() else t)(torch.as_tensor(a)))
    def _A_setup():
        B, H, Sq, Sk, D, M = 1, 32, 1, 16384, 128, 640
        Dc = 4 * D
        return {
            "x": _w((lambda *s: torch.randn(*s, dtype=torch.bfloat16) * 0.05)(B, Sq, M)),
            "c_kv": _w((lambda *s: torch.randn(*s, dtype=torch.bfloat16) * 0.4)(B, Sk, Dc)),
            "w_q": _w((lambda *s: torch.randn(*s, dtype=torch.bfloat16) * 3.2)(M, H, D) * (M ** -0.5)),
            "w_uk": _w((lambda *s: torch.randn(*s, dtype=torch.bfloat16) * 3.2)(Dc, H, D) * (Dc ** -0.5)),
            "w_uv": _w((lambda *s: torch.randn(*s, dtype=torch.bfloat16) * 0.4)(Dc, H, D) * (Dc ** -0.5)),
            "w_o": _w((lambda *s: torch.randn(*s, dtype=torch.bfloat16) * 0.4)(H, D, M) * ((H * D) ** -0.5)),
        }
    _A_in = _A_setup()

    def _B_setup():
        B, S, D, F = 1, 1, 640, 1728
        return {
            "x": _w((lambda *s: torch.randn(*s, dtype=torch.bfloat16) * 0.05)(B, S, D)),
            "w1": _w((lambda *s: torch.randn(*s, dtype=torch.bfloat16) * 0.05)(D, F)),
            "b1": _w((lambda *s: torch.randn(*s, dtype=torch.bfloat16) * 0.4)(F)),
            "w2": _w((lambda *s: torch.randn(*s, dtype=torch.bfloat16) * 0.05)(F, D)),
            "b2": _w((lambda *s: torch.randn(*s, dtype=torch.bfloat16) * 1.6)(D)),
        }
    _B_in = _B_setup()

    return {
        "A_x": _A_in["x"],
        "A_c_kv": _A_in["c_kv"],
        "A_w_q": _A_in["w_q"],
        "A_w_uk": _A_in["w_uk"],
        "A_w_uv": _A_in["w_uv"],
        "A_w_o": _A_in["w_o"],
        "B_x": _B_in["x"],
        "B_w1": _B_in["w1"],
        "B_b1": _B_in["b1"],
        "B_w2": _B_in["w2"],
        "B_b2": _B_in["b2"],
    }

def reference(A_x, A_c_kv, A_w_q, A_w_uk, A_w_uv, A_w_o, B_x, B_w1, B_b1, B_w2, B_b2):
    def _A_ref(x, c_kv, w_q, w_uk, w_uv, w_o):
        B, Sq, M = x.shape[0], x.shape[1], x.shape[2]
        Sk = c_kv.shape[1]
        H, D = w_q.shape[1], w_q.shape[2]
        q = torch.einsum("bqm,mhd->bhqd", x, w_q)
        k = torch.einsum("bkc,chd->bhkd", c_kv, w_uk)
        v = torch.einsum("bkc,chd->bhkd", c_kv, w_uv)
        scores = torch.einsum("bhqd,bhkd->bhqk", q, k) * (D ** -0.5)
        off = Sk - Sq
        qi = torch.arange(Sq)[:, None]
        kj = torch.arange(Sk)[None, :]
        cmask = kj <= (qi + off)
        scores = torch.where(cmask[None, None], scores, -1e9)
        p = _softmax(scores, axis=-1)
        ctx = torch.einsum("bhqk,bhkd->bhqd", p, v)
        return torch.einsum("bhqd,hdm->bqm", ctx, w_o)

    def _B_ref(x, w1, b1, w2, b2):
        h = torch.einsum("bsd,df->bsf", x, w1) + b1
        zero = torch.zeros_like(h)
        r = torch.where(h > zero, h, zero)
        h = r * r
        out = torch.einsum("bsf,fd->bsd", h, w2) + b2
        return out

    x = A_x
    h = x + _A_ref(_layernorm(x, axis=-1), A_c_kv, A_w_q, A_w_uk, A_w_uv, A_w_o)
    h2 = h + _B_ref(_layernorm(h, axis=-1), B_w1, B_b1, B_w2, B_b2)
    return h2
```

```asm
; @launch grid=(256,1,1) block=(512,1,1) lds=163840
.amdgcn_target "amdgcn-amd-amdhsa--gfx950"
.text
.globl sequential_preLN__compressed_kv_cla__dense_activation_squared_relu__decode_kernel
.p2align 12
.p2align 8
.type sequential_preLN__compressed_kv_cla__dense_activation_squared_relu__decode_kernel,@function
sequential_preLN__compressed_kv_cla__dense_activation_squared_relu__decode_kernel:
    s_load_dwordx16 s[16:31], s[0:1], 0
    s_load_dwordx8 s[32:39], s[0:1], 64
    s_load_dwordx2 s[42:43], s[0:1], 104
    v_readfirstlane_b32 s3, v0
    s_cmp_ge_u32 s2, 256
    s_cbranch_scc1 L_END
    v_and_b32 v0, 63, v0
    s_and_b32 s4, s2, 7
    s_lshr_b32 s5, s2, 3
    s_lshr_b32 s3, s3, 6
    v_and_b32 v1, 15, v0
    v_lshrrev_b32 v2, 4, v0
    s_mov_b32 s70, 0x100000
    v_mov_b32 v3, 162816
    v_mov_b32 v4, 1
    s_cmp_ge_u32 s5, 16
    s_cbranch_scc1 L_A
    s_lshr_b32 s8, s5, 2
    s_lshl_b32 s6, s4, 2
    s_add_u32 s6, s6, s8
    s_mul_i32 s8, s8, 9
    s_xor_b32 s71, s8, s4
    s_and_b32 s7, s5, 3
    s_cmp_eq_u32 s3, 5
    s_cbranch_scc1 L_W5
    s_cmp_ge_u32 s3, 4
    s_cbranch_scc1 L_W4
    s_lshl_b32 s8, s7, 2
    s_add_u32 s10, s8, s3
    s_mul_i32 s8, s10, 40*8192
    s_lshl_b32 s9, s71, 8
    s_add_u32 s8, s8, s9
    v_mul_u32_u24 v5, 10*8192, v2
    v_lshlrev_b32 v6, 4, v1
    v_add3_u32 v40, v5, v6, s8
    s_movk_i32 s9, 0x2000
    v_add_u32 v44, s9, v40
    v_add_u32 v48, s9, v44
    v_add_u32 v52, s9, v48
    v_add_u32 v56, s9, v52
    v_add_u32 v60, s9, v56
    v_add_u32 v64, s9, v60
    v_add_u32 v68, s9, v64
    v_add_u32 v72, s9, v68
    v_add_u32 v76, s9, v72
    s_mul_i32 s8, s10, 80
    v_mul_u32_u24 v7, 20, v2
    v_add_u32 v7, s8, v7
    v_mul_u32_u24 v5, 9, v2
    v_xor_b32 v5, s4, v5
    v_lshlrev_b32 v5, 8, v5
    v_xor_b32 v6, s3, v1
    v_lshl_add_u32 v20, v6, 4, v5
    s_lshl_b32 s15, s5, 18
    s_lshl_b32 s9, s3, 16
    s_add_u32 s15, s15, s9
    s_lshl_b32 s11, s3, 13
    s_waitcnt lgkmcnt(0)
    global_load_dwordx4 v[12:15], v7, s[16:17]
    global_load_dword v16, v7, s[16:17] offset:16
    global_load_dwordx4 v[40:43], v40, s[20:21] nt
    global_load_dwordx4 v[44:47], v44, s[20:21] nt
    global_load_dwordx4 v[48:51], v48, s[20:21] nt
    global_load_dwordx4 v[52:55], v52, s[20:21] nt
    global_load_dwordx4 v[56:59], v56, s[20:21] nt
    global_load_dwordx4 v[60:63], v60, s[20:21] nt
    global_load_dwordx4 v[64:67], v64, s[20:21] nt
    global_load_dwordx4 v[68:71], v68, s[20:21] nt
    global_load_dwordx4 v[72:75], v72, s[20:21] nt
    global_load_dwordx4 v[76:79], v76, s[20:21] nt
    s_load_dword s40, s[42:43], 131072
    s_mov_b32 s48, s22
    s_mov_b32 s49, s23
    s_mov_b32 s50, 4194304
    s_mov_b32 s51, 0x20000
    v_xor_b32 v21, 64, v20
    v_xor_b32 v22, 128, v20
    v_xor_b32 v23, 192, v20
    v_cmp_gt_u32 vcc, 8, v1
    v_mov_b32 v5, 0x0100
    v_mov_b32 v6, 0x0504
    v_mov_b32 v7, 0x0706
    v_cndmask_b32 v6, v5, v6, vcc
    v_cndmask_b32 v7, v5, v7, vcc
    v_and_b32 v5, 1, v0
    v_lshlrev_b32 v5, 4, v5
    v_lshlrev_b32 v6, v5, v6
    v_lshlrev_b32 v7, v5, v7
    v_mov_b32 v17, 0x0c0c0000
    v_lshrrev_b32 v17, v5, v17
    v_or_b32 v6, v6, v17
    v_or_b32 v7, v7, v17
    v_and_b32 v5, 7, v0
    v_lshrrev_b32 v5, 1, v5
    v_mov_b32 v17, 0x0c0c0c0c
    v_cmp_eq_u32 vcc, 0, v5
    s_nop 1
    v_cndmask_b32 v24, v17, v6, vcc
    v_cndmask_b32 v28, v17, v7, vcc
    v_cmp_eq_u32 vcc, 1, v5
    s_nop 1
    v_cndmask_b32 v25, v17, v6, vcc
    v_cndmask_b32 v29, v17, v7, vcc
    v_cmp_eq_u32 vcc, 2, v5
    s_nop 1
    v_cndmask_b32 v26, v17, v6, vcc
    v_cndmask_b32 v30, v17, v7, vcc
    v_cmp_eq_u32 vcc, 3, v5
    s_nop 1
    v_cndmask_b32 v27, v17, v6, vcc
    v_cndmask_b32 v31, v17, v7, vcc
    v_mov_b32 v17, 0x3f803f80
    s_lshl_b32 s8, s3, 10
    s_add_u32 s8, s8, 135680
    v_lshl_add_u32 v18, v0, 4, s8
    s_waitcnt vmcnt(10)
    v_perm_b32 v80, v12, v17, v24
    v_perm_b32 v81, v12, v17, v25
    v_perm_b32 v82, v12, v17, v26
    v_perm_b32 v83, v12, v17, v27
    s_waitcnt vmcnt(9)
    s_nop 0
    v_mfma_f32_16x16x32_bf16 v[36:39], v[80:83], v[40:43], 0
    v_perm_b32 v84, v12, v17, v28
    v_perm_b32 v85, v12, v17, v29
    v_perm_b32 v86, v12, v17, v30
    v_perm_b32 v87, v12, v17, v31
    s_waitcnt vmcnt(8)
    s_nop 0
    v_mfma_f32_16x16x32_bf16 v[36:39], v[84:87], v[44:47], v[36:39]
    v_perm_b32 v80, v13, v17, v24
    v_perm_b32 v81, v13, v17, v25
    v_perm_b32 v82, v13, v17, v26
    v_perm_b32 v83, v13, v17, v27
    s_waitcnt vmcnt(7)
    s_add_u32 m0, s11, 0
    s_add_u32 s14, s15, 0
    buffer_load_dwordx4 v20, s[48:51], s14 offen nt lds
    v_mfma_f32_16x16x32_bf16 v[36:39], v[80:83], v[48:51], v[36:39]
    v_perm_b32 v84, v13, v17, v28
    v_perm_b32 v85, v13, v17, v29
    v_perm_b32 v86, v13, v17, v30
    v_perm_b32 v87, v13, v17, v31
    s_waitcnt vmcnt(7)
    s_add_u32 m0, s11, 1024
    s_add_u32 s14, s15, 8192
    buffer_load_dwordx4 v20, s[48:51], s14 offen nt lds
    v_mfma_f32_16x16x32_bf16 v[36:39], v[84:87], v[52:55], v[36:39]
    v_perm_b32 v80, v14, v17, v24
    v_perm_b32 v81, v14, v17, v25
    v_perm_b32 v82, v14, v17, v26
    v_perm_b32 v83, v14, v17, v27
    s_waitcnt vmcnt(7)
    s_add_u32 m0, s11, 2048
    s_add_u32 s14, s15, 16384
    buffer_load_dwordx4 v21, s[48:51], s14 offen nt lds
    v_mfma_f32_16x16x32_bf16 v[36:39], v[80:83], v[56:59], v[36:39]
    v_perm_b32 v84, v14, v17, v28
    v_perm_b32 v85, v14, v17, v29
    v_perm_b32 v86, v14, v17, v30
    v_perm_b32 v87, v14, v17, v31
    s_waitcnt vmcnt(7)
    s_add_u32 m0, s11, 3072
    s_add_u32 s14, s15, 24576
    buffer_load_dwordx4 v21, s[48:51], s14 offen nt lds
    v_mfma_f32_16x16x32_bf16 v[36:39], v[84:87], v[60:63], v[36:39]
    v_perm_b32 v80, v15, v17, v24
    v_perm_b32 v81, v15, v17, v25
    v_perm_b32 v82, v15, v17, v26
    v_perm_b32 v83, v15, v17, v27
    s_waitcnt vmcnt(7)
    s_add_u32 m0, s11, 4096
    s_add_u32 s14, s15, 32768
    buffer_load_dwordx4 v22, s[48:51], s14 offen nt lds
    v_mfma_f32_16x16x32_bf16 v[36:39], v[80:83], v[64:67], v[36:39]
    v_perm_b32 v84, v15, v17, v28
    v_perm_b32 v85, v15, v17, v29
    v_perm_b32 v86, v15, v17, v30
    v_perm_b32 v87, v15, v17, v31
    s_waitcnt vmcnt(7)
    s_add_u32 m0, s11, 5120
    s_add_u32 s14, s15, 40960
    buffer_load_dwordx4 v22, s[48:51], s14 offen nt lds
    v_mfma_f32_16x16x32_bf16 v[36:39], v[84:87], v[68:71], v[36:39]
    v_perm_b32 v80, v16, v17, v24
    v_perm_b32 v81, v16, v17, v25
    v_perm_b32 v82, v16, v17, v26
    v_perm_b32 v83, v16, v17, v27
    s_waitcnt vmcnt(7)
    s_add_u32 m0, s11, 6144
    s_add_u32 s14, s15, 49152
    buffer_load_dwordx4 v23, s[48:51], s14 offen nt lds
    v_mfma_f32_16x16x32_bf16 v[36:39], v[80:83], v[72:75], v[36:39]
    v_perm_b32 v84, v16, v17, v28
    v_perm_b32 v85, v16, v17, v29
    v_perm_b32 v86, v16, v17, v30
    v_perm_b32 v87, v16, v17, v31
    s_waitcnt vmcnt(7)
    s_add_u32 m0, s11, 7168
    s_add_u32 s14, s15, 57344
    buffer_load_dwordx4 v23, s[48:51], s14 offen nt lds
    v_mfma_f32_16x16x32_bf16 v[36:39], v[84:87], v[76:79], v[36:39]
    s_nop 7
    ds_write_b128 v18, v[36:39]
    s_waitcnt lgkmcnt(0)
    s_barrier
    s_waitcnt lgkmcnt(0)
    s_add_u32 s40, s40, 0x11111111
    s_mov_b32 s41, 0xfffefffe
    s_mov_b32 s29, 0x07060302
    s_mov_b32 s28, 0x00010001
    s_mov_b32 s44, s42
    s_mov_b32 s45, s43
    s_mov_b32 s46, 268435456
    s_mov_b32 s47, 0x20000
    s_not_b32 s8, s40
    v_and_b32 v5, 3, v0
    v_lshlrev_b32 v5, 2, v5
    v_lshrrev_b32 v5, v5, s8
    v_lshrrev_b32 v6, 0, v5
    v_and_b32 v8, s28, v6
    v_lshrrev_b32 v6, 1, v5
    v_and_b32 v9, s28, v6
    v_lshrrev_b32 v6, 2, v5
    v_and_b32 v10, s28, v6
    v_lshrrev_b32 v6, 3, v5
    v_and_b32 v11, s28, v6
    s_mul_i32 s8, s4, 135168
    s_lshl_b32 s9, s3, 10
    s_add_u32 s8, s8, s9
    s_add_u32 s52, s8, 6291456
    s_add_u32 s53, s52, 32768
    s_mov_b32 s54, s52
    s_mov_b32 s55, 0
    v_lshrrev_b32 v5, 2, v1
    v_lshlrev_b32 v12, 8, v5
    v_lshl_add_u32 v12, v2, 6, v12
    v_and_b32 v6, 3, v1
    v_lshl_add_u32 v12, v6, 4, v12
    s_sleep 10
    buffer_load_dwordx4 v[72:75], v12, s[44:47], s54 offen sc1
    v_lshl_add_u32 v5, v6, 2, v5
    v_lshlrev_b32 v6, 2, v2
    v_xor_b32 v5, v5, v6
    s_lshl_b32 s8, s3, 8
    s_add_u32 s8, s8, 0
    v_lshl_add_u32 v6, v1, 11, s8
    v_xor_b32 v7, 0, v5
    v_lshl_add_u32 v13, v7, 4, v6
    v_xor_b32 v7, 1, v5
    v_lshl_add_u32 v14, v7, 4, v6
    v_xor_b32 v7, 2, v5
    v_lshl_add_u32 v15, v7, 4, v6
    v_xor_b32 v7, 3, v5
    v_lshl_add_u32 v16, v7, 4, v6
    s_mul_i32 s8, s4, 135168
    s_lshl_b32 s9, s5, 8
    s_add_u32 s8, s8, s9
    s_lshl_b32 s9, s3, 6
    s_add_u32 s8, s8, s9
    s_add_u32 s8, s8, 7340032
    v_lshlrev_b32 v17, 15, v2
    v_lshl_add_u32 v17, v1, 2, v17
    v_add_u32 v17, s8, v17
    v_lshrrev_b32 v18, v1, s40
    v_and_b32 v18, s28, v18
    s_waitcnt vmcnt(1)
    s_mov_b64 exec, 1
    ds_add_u32 v3, v4 offset:200
    s_mov_b64 exec, -1
L_H1:
    s_waitcnt vmcnt(0)
    v_xor_b32 v72, v72, v8
    v_xor_b32 v73, v73, v9
    v_xor_b32 v74, v74, v10
    v_xor_b32 v75, v75, v11
    v_bitop3_b32 v5, v72, v73, v74 bitop3:0x80
    v_bitop3_b32 v5, v5, v75, s28 bitop3:0x80
    v_cmp_ne_u32 vcc, s28, v5
    s_cbranch_vccnz L_H0
    s_mov_b64 exec, 1
    ds_add_u32 v3, v4 offset:48
    s_mov_b64 exec, -1
LW_1:
    ds_read_b32 v5, v3 offset:200
    ds_read_b128 v[40:43], v13 offset:0
    ds_read_b128 v[44:47], v13 offset:1024
    ds_read_b128 v[48:51], v14 offset:0
    ds_read_b128 v[52:55], v14 offset:1024
    ds_read_b128 v[56:59], v15 offset:0
    ds_read_b128 v[60:63], v15 offset:1024
    ds_read_b128 v[64:67], v16 offset:0
    ds_read_b128 v[68:71], v16 offset:1024
    s_sub_u32 s70, s70, 1
    s_cbranch_scc1 L_EXIT
    s_waitcnt lgkmcnt(0)
    v_cmp_le_u32 vcc, 4, v5
    s_cbranch_vccz LW_1
    v_mfma_f32_16x16x32_bf16 v[88:91], v[72:75], v[40:43], 0
    v_mfma_f32_16x16x32_bf16 v[104:107], v[72:75], v[44:47], 0
    v_mfma_f32_16x16x32_bf16 v[92:95], v[72:75], v[48:51], 0
    v_mfma_f32_16x16x32_bf16 v[108:111], v[72:75], v[52:55], 0
    v_mfma_f32_16x16x32_bf16 v[96:99], v[72:75], v[56:59], 0
    v_mfma_f32_16x16x32_bf16 v[112:115], v[72:75], v[60:63], 0
    v_mfma_f32_16x16x32_bf16 v[100:103], v[72:75], v[64:67], 0
    v_mfma_f32_16x16x32_bf16 v[116:119], v[72:75], v[68:71], 0
    s_nop 2
    v_add_f32 v88, v88, v93
    v_add_f32 v104, v104, v109
    v_add_f32 v88, v88, v98
    v_add_f32 v104, v104, v114
    v_add_f32 v88, v88, v103
    v_add_f32 v104, v104, v119
    s_nop 1
    v_permlane32_swap_b32 v88, v104
    v_add_f32 v88, v88, v104
    v_mov_b32 v92, v88
    s_nop 1
    v_permlane16_swap_b32 v88, v92
    v_add_f32 v88, v88, v92
    v_mov_b32 v92, v88
    s_nop 1
    v_permlane32_swap_b32 v88, v92
    v_perm_b32 v88, v92, v88, s29
    v_and_or_b32 v88, v88, s41, v18
    s_mov_b64 exec, 0xffff
    global_store_dword v17, v88, s[42:43] sc1
    s_mov_b64 exec, 1
    ds_add_u32 v3, v4 offset:8
    s_mov_b64 exec, -1
    s_lshl_b32 s8, s3, 14
    s_lshl_b32 s9, s6, 4
    s_add_u32 s8, s8, s9
    s_add_u32 s8, s8, 196608
    v_lshl_add_u32 v5, v1, 2, v2
    v_lshl_add_u32 v12, v5, 9, s8
    s_lshl_b32 s8, s6, 2
    s_add_u32 s8, s8, s7
    s_lshl_b32 s8, s8, 15
    s_lshl_b32 s9, s3, 13
    s_add_u32 s8, s8, s9
    s_add_u32 s52, s8, 1048576
    s_add_u32 s53, s52, 4096
    v_lshlrev_b32 v13, 4, v0
    v_and_b32 v5, 1, v0
    v_lshlrev_b32 v5, 4, v5
    v_mov_b32 v6, 0xffff
    v_lshlrev_b32 v6, v5, v6
    v_lshrrev_b32 v5, 1, v1
    v_cmp_eq_u32 vcc, 0, v5
    s_nop 1
    v_cndmask_b32 v24, 0, v6, vcc
    v_cmp_eq_u32 vcc, 1, v5
    s_nop 1
    v_cndmask_b32 v25, 0, v6, vcc
    v_cmp_eq_u32 vcc, 2, v5
    s_nop 1
    v_cndmask_b32 v26, 0, v6, vcc
    v_cmp_eq_u32 vcc, 3, v5
    s_nop 1
    v_cndmask_b32 v27, 0, v6, vcc
    s_mul_i32 s8, s3, 272
    s_add_u32 s8, s8, 140288
    v_lshlrev_b32 v14, 4, v1
    v_lshl_add_u32 v14, v2, 3, v14
    v_add_u32 v14, s8, v14
    v_mul_u32_u24 v15, 272, v1
    v_lshl_add_u32 v15, v2, 4, v15
    v_add_u32 v15, 140288, v15
    s_lshl_b32 s8, s3, 3
    s_add_u32 s8, s8, 141568
    v_mov_b32 v16, s8
    v_mov_b32 v17, 141568
    s_lshl_b32 s8, s6, 11
    s_lshl_b32 s9, s3, 9
    s_add_u32 s8, s8, s9
    s_lshl_b32 s9, s7, 7
    s_add_u32 s8, s8, s9
    s_add_u32 s8, s8, 393216
    v_lshl_add_u32 v18, v0, 2, s8
    v_lshrrev_b32 v5, 2, v0
    v_and_b32 v6, 3, v0
    v_lshlrev_b32 v6, 4, v6
    v_lshl_add_u32 v19, v5, 7, v6
    s_lshl_b32 s8, s4, 13
    s_lshl_b32 s9, s3, 11
    s_add_u32 s8, s8, s9
    s_add_u32 s54, s8, 393216
    s_lshl_b32 s8, s3, 2
    s_add_u32 s8, s8, 141824
    v_lshl_add_u32 v20, v0, 4, s8
    v_and_b32 v5, 31, v0
    v_lshlrev_b32 v21, 5, v5
    v_add_u32 v21, 141824, v21
    s_lshl_b32 s8, s5, 10
    s_lshl_b32 s9, s4, 7
    s_add_u32 s8, s8, s9
    s_add_u32 s55, s8, 458752
    s_add_u32 s56, s55, 20480
    v_lshrrev_b32 v6, 5, v0
    v_mul_u32_u24 v22, 10240, v6
    v_lshl_add_u32 v22, v5, 2, v22
    s_mov_b32 s58, 0x00ff00ff
    s_mov_b32 s59, 0x00ff00ff
    s_mov_b32 s60, 0x000f000f
    s_mov_b32 s61, 0x000f000f
    s_not_b32 s57, s40
    v_mov_b32 v28, 0xff800000
    v_mov_b32 v29, 0
    v_mov_b32 v30, s40
    v_mov_b32 v31, s57
    v_mov_b32 v200, 0
    v_mov_b32 v201, 0
    v_mov_b32 v202, 0
    v_mov_b32 v203, 0
    v_mov_b32 v204, 0
    v_mov_b32 v205, 0
    v_mov_b32 v206, 0
    v_mov_b32 v207, 0
    v_mov_b32 v208, 0
    v_mov_b32 v209, 0
    v_mov_b32 v210, 0
    v_mov_b32 v211, 0
    v_mov_b32 v212, 0
    v_mov_b32 v213, 0
    v_mov_b32 v214, 0
    v_mov_b32 v215, 0
    v_lshrrev_b32 v220, v1, s40
    v_and_b32 v220, s28, v220
    s_lshl_b32 s8, s4, 2
    s_lshl_b32 s9, s5, 10
    s_add_u32 s8, s8, s9
    s_add_u32 s8, s8, 180224
    v_lshl_add_u32 v222, v0, 7, s8
    v_mov_b32 v223, s40
    v_lshrrev_b32 v5, 2, v1
    v_and_b32 v6, 3, v1
    v_lshrrev_b32 v7, 1, v5
    v_and_b32 v5, 1, v5
    v_lshlrev_b32 v23, 5, v5
    v_lshl_add_u32 v23, v2, 2, v23
    v_add_u32 v23, v23, v7
    v_lshlrev_b32 v23, 8, v23
    v_and_b32 v36, 1, v6
    v_lshl_add_u32 v23, v36, 3, v23
    v_add_u32 v23, 32768, v23
    v_lshrrev_b32 v6, 1, v6
    s_lshl_b32 s8, s3, 2
    v_add_u32 v37, s8, v6
    v_lshl_add_u32 v38, v7, 2, v2
    v_xor_b32 v37, v37, v38
    v_xor_b32 v38, 0, v37
    v_lshl_add_u32 v32, v38, 4, v23
    v_xor_b32 v38, 8, v37
    v_lshl_add_u32 v33, v38, 4, v23
    v_xor_b32 v38, 2, v37
    v_lshl_add_u32 v34, v38, 4, v23
    v_xor_b32 v38, 10, v37
    v_lshl_add_u32 v35, v38, 4, v23
    v_lshlrev_b32 v23, 1, v2
    v_add_u32 v23, v23, v5
    v_lshl_add_u32 v37, v23, 4, v7
    v_lshlrev_b32 v37, 7, v37
    v_lshl_add_u32 v37, v36, 3, v37
    s_lshl_b32 s8, s3, 14
    s_add_u32 s8, s8, 65536
    v_add_u32 v37, s8, v37
    v_and_b32 v23, 3, v23
    v_lshl_add_u32 v23, v23, 1, v6
    v_xor_b32 v38, 0, v23
    v_lshl_add_u32 v216, v38, 4, v37
    v_xor_b32 v38, 2, v23
    v_lshl_add_u32 v217, v38, 4, v37
    v_xor_b32 v38, 4, v23
    v_lshl_add_u32 v218, v38, 4, v37
    v_xor_b32 v38, 6, v23
    v_lshl_add_u32 v219, v38, 4, v37
LW_2:
    ds_read_b32 v5, v3 offset:204
    s_sub_u32 s70, s70, 1
    s_cbranch_scc1 L_EXIT
    s_waitcnt lgkmcnt(0)
    v_cmp_le_u32 vcc, 2, v5
    s_cbranch_vccnz LK_3
    s_sleep 2
    s_branch LW_2
LK_3:
    ds_read_b64_tr_b16 v[104:105], v32 offset:0
    ds_read_b64_tr_b16 v[106:107], v33 offset:512
    ds_read_b64_tr_b16 v[108:109], v32 offset:4096
    ds_read_b64_tr_b16 v[110:111], v33 offset:4608
    ds_read_b64_tr_b16 v[112:113], v32 offset:16384
    ds_read_b64_tr_b16 v[114:115], v33 offset:16896
    ds_read_b64_tr_b16 v[116:117], v32 offset:20480
    ds_read_b64_tr_b16 v[118:119], v33 offset:20992
    ds_read_b64_tr_b16 v[120:121], v34 offset:0
    ds_read_b64_tr_b16 v[122:123], v35 offset:512
    ds_read_b64_tr_b16 v[124:125], v34 offset:4096
    ds_read_b64_tr_b16 v[126:127], v35 offset:4608
    ds_read_b64_tr_b16 v[128:129], v34 offset:16384
    ds_read_b64_tr_b16 v[130:131], v35 offset:16896
    ds_read_b64_tr_b16 v[132:133], v34 offset:20480
    ds_read_b64_tr_b16 v[134:135], v35 offset:20992
    s_mov_b32 s62, 0
    s_mov_b32 s63, 458752
    s_mov_b32 s64, s54
    s_add_u32 s65, s54, 458752
    s_lshl_b32 s8, s3, 2
    v_add_u32 v7, s8, v3
L_CW:
    ds_read_b32 v5, v3 offset:208
    ds_read_b32 v6, v7 offset:224
    s_sub_u32 s70, s70, 1
    s_cbranch_scc1 L_EXIT
    s_waitcnt lgkmcnt(0)
    v_cmp_le_u32 vcc, 1, v6
    s_cbranch_vccnz L_NOWO
    v_cmp_le_u32 vcc, 2, v5
    s_cbranch_vccnz L_CW2
    s_sleep 1
    s_branch L_CW
L_CW2:
    ds_read_b64_tr_b16 v[136:137], v216 offset:0
    ds_read_b64_tr_b16 v[138:139], v216 offset:256
    ds_read_b64_tr_b16 v[140:141], v216 offset:512
    ds_read_b64_tr_b16 v[142:143], v216 offset:768
    ds_read_b64_tr_b16 v[144:145], v216 offset:1024
    ds_read_b64_tr_b16 v[146:147], v216 offset:1280
    ds_read_b64_tr_b16 v[148:149], v216 offset:1536
    ds_read_b64_tr_b16 v[150:151], v216 offset:1792
    ds_read_b64_tr_b16 v[152:153], v217 offset:0
    ds_read_b64_tr_b16 v[154:155], v217 offset:256
    ds_read_b64_tr_b16 v[156:157], v217 offset:512
    ds_read_b64_tr_b16 v[158:159], v217 offset:768
    ds_read_b64_tr_b16 v[160:161], v217 offset:1024
    ds_read_b64_tr_b16 v[162:163], v217 offset:1280
    ds_read_b64_tr_b16 v[164:165], v217 offset:1536
    ds_read_b64_tr_b16 v[166:167], v217 offset:1792
    ds_read_b64_tr_b16 v[168:169], v218 offset:0
    ds_read_b64_tr_b16 v[170:171], v218 offset:256
    ds_read_b64_tr_b16 v[172:173], v218 offset:512
    ds_read_b64_tr_b16 v[174:175], v218 offset:768
    ds_read_b64_tr_b16 v[176:177], v218 offset:1024
    ds_read_b64_tr_b16 v[178:179], v218 offset:1280
    ds_read_b64_tr_b16 v[180:181], v218 offset:1536
    ds_read_b64_tr_b16 v[182:183], v218 offset:1792
    ds_read_b64_tr_b16 v[184:185], v219 offset:0
    ds_read_b64_tr_b16 v[186:187], v219 offset:256
    ds_read_b64_tr_b16 v[188:189], v219 offset:512
    ds_read_b64_tr_b16 v[190:191], v219 offset:768
    ds_read_b64_tr_b16 v[192:193], v219 offset:1024
    ds_read_b64_tr_b16 v[194:195], v219 offset:1280
    ds_read_b64_tr_b16 v[196:197], v219 offset:1536
    ds_read_b64_tr_b16 v[198:199], v219 offset:1792
    s_mov_b32 s62, 1
LW_4:
    ds_read_b32 v5, v7 offset:224
    s_sub_u32 s70, s70, 1
    s_cbranch_scc1 L_EXIT
    s_waitcnt lgkmcnt(0)
    v_cmp_le_u32 vcc, 1, v5
    s_cbranch_vccnz LK_5
    s_sleep 1
    s_branch LW_4
LK_5:
L_NOWO:
    s_sleep 3
    s_mov_b64 exec, s[58:59]
    global_load_dwordx4 v[28:31], v12, s[42:43] sc1
    s_mov_b64 exec, -1
    s_waitcnt vmcnt(0)
    v_xor_b32 v5, s40, v30
    v_xor_b32 v6, s57, v31
    v_or_b32 v5, v5, v6
    v_cmp_ne_u32 vcc, 0, v5
    s_cbranch_vccnz L_STR
L_STD:
    buffer_load_dwordx4 v[40:43], v13, s[44:47], s52 offen offset:0 sc1
    buffer_load_dwordx4 v[44:47], v13, s[44:47], s52 offen offset:1024 sc1
    buffer_load_dwordx4 v[48:51], v13, s[44:47], s52 offen offset:2048 sc1
    buffer_load_dwordx4 v[52:55], v13, s[44:47], s52 offen offset:3072 sc1
    buffer_load_dwordx4 v[56:59], v13, s[44:47], s53 offen offset:0 sc1
    buffer_load_dwordx4 v[60:63], v13, s[44:47], s53 offen offset:1024 sc1
    buffer_load_dwordx4 v[64:67], v13, s[44:47], s53 offen offset:2048 sc1
    buffer_load_dwordx4 v[68:71], v13, s[44:47], s53 offen offset:3072 sc1
L_STE:
    v_max_f32_dpp v6, v28, v28 quad_perm:[1,0,3,2] row_mask:0xf bank_mask:0xf
    s_nop 1
    v_max_f32_dpp v6, v6, v6 quad_perm:[2,3,0,1] row_mask:0xf bank_mask:0xf
    s_nop 1
    v_max_f32_dpp v6, v6, v6 row_half_mirror row_mask:0xf bank_mask:0xf
    s_nop 1
    v_max_f32_dpp v6, v6, v6 row_mirror row_mask:0xf bank_mask:0xf
    v_mov_b32 v7, v6
    s_nop 1
    v_permlane16_swap_b32 v6, v7
    v_max_f32 v6, v6, v7
    v_mov_b32 v7, v6
    s_nop 1
    v_permlane32_swap_b32 v6, v7
    v_max_f32 v6, v6, v7
    v_sub_f32 v28, v28, v6
    v_exp_f32 v28, v28
    s_nop 0
    v_cvt_pk_bf16_f32 v28, v28, v28
    v_and_b32 v7, 0xffff0000, v28
    v_mul_f32 v7, v7, v29
    v_and_b32_dpp v72, v28, v24 row_newbcast:0 row_mask:0xf bank_mask:0xf
    v_and_b32_dpp v73, v28, v25 row_newbcast:0 row_mask:0xf bank_mask:0xf
    v_and_b32_dpp v74, v28, v26 row_newbcast:0 row_mask:0xf bank_mask:0xf
    v_and_b32_dpp v75, v28, v27 row_newbcast:0 row_mask:0xf bank_mask:0xf
    v_and_b32_dpp v76, v28, v24 row_newbcast:1 row_mask:0xf bank_mask:0xf
    v_and_b32_dpp v77, v28, v25 row_newbcast:1 row_mask:0xf bank_mask:0xf
    v_and_b32_dpp v78, v28, v26 row_newbcast:1 row_mask:0xf bank_mask:0xf
    v_and_b32_dpp v79, v28, v27 row_newbcast:1 row_mask:0xf bank_mask:0xf
    v_and_b32_dpp v80, v28, v24 row_newbcast:2 row_mask:0xf bank_mask:0xf
    v_and_b32_dpp v81, v28, v25 row_newbcast:2 row_mask:0xf bank_mask:0xf
    v_and_b32_dpp v82, v28, v26 row_newbcast:2 row_mask:0xf bank_mask:0xf
    v_and_b32_dpp v83, v28, v27 row_newbcast:2 row_mask:0xf bank_mask:0xf
    v_and_b32_dpp v84, v28, v24 row_newbcast:3 row_mask:0xf bank_mask:0xf
    v_and_b32_dpp v85, v28, v25 row_newbcast:3 row_mask:0xf bank_mask:0xf
    v_and_b32_dpp v86, v28, v26 row_newbcast:3 row_mask:0xf bank_mask:0xf
    v_and_b32_dpp v87, v28, v27 row_newbcast:3 row_mask:0xf bank_mask:0xf
    v_and_b32_dpp v88, v28, v24 row_newbcast:4 row_mask:0xf bank_mask:0xf
    v_and_b32_dpp v89, v28, v25 row_newbcast:4 row_mask:0xf bank_mask:0xf
    v_and_b32_dpp v90, v28, v26 row_newbcast:4 row_mask:0xf bank_mask:0xf
    v_and_b32_dpp v91, v28, v27 row_newbcast:4 row_mask:0xf bank_mask:0xf
    v_and_b32_dpp v92, v28, v24 row_newbcast:5 row_mask:0xf bank_mask:0xf
    v_and_b32_dpp v93, v28, v25 row_newbcast:5 row_mask:0xf bank_mask:0xf
    v_and_b32_dpp v94, v28, v26 row_newbcast:5 row_mask:0xf bank_mask:0xf
    v_and_b32_dpp v95, v28, v27 row_newbcast:5 row_mask:0xf bank_mask:0xf
    v_and_b32_dpp v96, v28, v24 row_newbcast:6 row_mask:0xf bank_mask:0xf
    v_and_b32_dpp v97, v28, v25 row_newbcast:6 row_mask:0xf bank_mask:0xf
    v_and_b32_dpp v98, v28, v26 row_newbcast:6 row_mask:0xf bank_mask:0xf
    v_and_b32_dpp v99, v28, v27 row_newbcast:6 row_mask:0xf bank_mask:0xf
    v_and_b32_dpp v100, v28, v24 row_newbcast:7 row_mask:0xf bank_mask:0xf
    v_and_b32_dpp v101, v28, v25 row_newbcast:7 row_mask:0xf bank_mask:0xf
    v_and_b32_dpp v102, v28, v26 row_newbcast:7 row_mask:0xf bank_mask:0xf
    v_and_b32_dpp v103, v28, v27 row_newbcast:7 row_mask:0xf bank_mask:0xf
    v_add_f32_dpp v7, v7, v7 quad_perm:[1,0,3,2] row_mask:0xf bank_mask:0xf
    s_nop 1
    v_add_f32_dpp v7, v7, v7 quad_perm:[2,3,0,1] row_mask:0xf bank_mask:0xf
    s_nop 1
    v_add_f32_dpp v7, v7, v7 row_half_mirror row_mask:0xf bank_mask:0xf
    s_nop 1
    v_add_f32_dpp v7, v7, v7 row_mirror row_mask:0xf bank_mask:0xf
    v_mov_b32 v23, v7
    s_nop 1
    v_permlane16_swap_b32 v7, v23
    v_add_f32 v7, v7, v23
    v_mov_b32 v23, v7
    s_nop 1
    v_permlane32_swap_b32 v7, v23
    v_add_f32 v7, v7, v23
    s_mov_b64 exec, 1
    ds_write_b64 v16, v[6:7]
    s_mov_b64 exec, -1
L_OC:
    v_mov_b32 v5, s28
    s_waitcnt vmcnt(7)
    v_xor_b32 v40, v40, v8
    v_xor_b32 v41, v41, v9
    v_xor_b32 v42, v42, v10
    v_xor_b32 v43, v43, v11
    v_bitop3_b32 v5, v5, v40, v41 bitop3:0x80
    v_bitop3_b32 v5, v5, v42, v43 bitop3:0x80
    v_mfma_f32_16x16x32_bf16 v[36:39], v[72:75], v[40:43], 0
    s_waitcnt vmcnt(6)
    v_xor_b32 v44, v44, v8
    v_xor_b32 v45, v45, v9
    v_xor_b32 v46, v46, v10
    v_xor_b32 v47, v47, v11
    v_bitop3_b32 v5, v5, v44, v45 bitop3:0x80
    v_bitop3_b32 v5, v5, v46, v47 bitop3:0x80
    v_mfma_f32_16x16x32_bf16 v[36:39], v[76:79], v[44:47], v[36:39]
    s_waitcnt vmcnt(5)
    v_xor_b32 v48, v48, v8
    v_xor_b32 v49, v49, v9
    v_xor_b32 v50, v50, v10
    v_xor_b32 v51, v51, v11
    v_bitop3_b32 v5, v5, v48, v49 bitop3:0x80
    v_bitop3_b32 v5, v5, v50, v51 bitop3:0x80
    v_mfma_f32_16x16x32_bf16 v[36:39], v[80:83], v[48:51], v[36:39]
    s_waitcnt vmcnt(4)
    v_xor_b32 v52, v52, v8
    v_xor_b32 v53, v53, v9
    v_xor_b32 v54, v54, v10
    v_xor_b32 v55, v55, v11
    v_bitop3_b32 v5, v5, v52, v53 bitop3:0x80
    v_bitop3_b32 v5, v5, v54, v55 bitop3:0x80
    v_mfma_f32_16x16x32_bf16 v[36:39], v[84:87], v[52:55], v[36:39]
    s_waitcnt vmcnt(3)
    v_xor_b32 v56, v56, v8
    v_xor_b32 v57, v57, v9
    v_xor_b32 v58, v58, v10
    v_xor_b32 v59, v59, v11
    v_bitop3_b32 v5, v5, v56, v57 bitop3:0x80
    v_bitop3_b32 v5, v5, v58, v59 bitop3:0x80
    v_mfma_f32_16x16x32_bf16 v[36:39], v[88:91], v[56:59], v[36:39]
    s_waitcnt vmcnt(2)
    v_xor_b32 v60, v60, v8
    v_xor_b32 v61, v61, v9
    v_xor_b32 v62, v62, v10
    v_xor_b32 v63, v63, v11
    v_bitop3_b32 v5, v5, v60, v61 bitop3:0x80
    v_bitop3_b32 v5, v5, v62, v63 bitop3:0x80
    v_mfma_f32_16x16x32_bf16 v[36:39], v[92:95], v[60:63], v[36:39]
    s_waitcnt vmcnt(1)
    v_xor_b32 v64, v64, v8
    v_xor_b32 v65, v65, v9
    v_xor_b32 v66, v66, v10
    v_xor_b32 v67, v67, v11
    v_bitop3_b32 v5, v5, v64, v65 bitop3:0x80
    v_bitop3_b32 v5, v5, v66, v67 bitop3:0x80
    v_mfma_f32_16x16x32_bf16 v[36:39], v[96:99], v[64:67], v[36:39]
    s_waitcnt vmcnt(0)
    v_xor_b32 v68, v68, v8
    v_xor_b32 v69, v69, v9
    v_xor_b32 v70, v70, v10
    v_xor_b32 v71, v71, v11
    v_bitop3_b32 v5, v5, v68, v69 bitop3:0x80
    v_bitop3_b32 v5, v5, v70, v71 bitop3:0x80
    v_mfma_f32_16x16x32_bf16 v[36:39], v[100:103], v[68:71], v[36:39]
    v_cmp_ne_u32 vcc, s28, v5
    s_cbranch_vccnz L_OR
    s_nop 5
    v_cvt_pk_bf16_f32 v36, v36, v37
    v_cvt_pk_bf16_f32 v37, v38, v39
    s_mov_b32 exec_hi, 0
    ds_write_b64 v14, v[36:37]
    s_mov_b64 exec, 1
    ds_add_u32 v3, v4 offset:28
    s_mov_b64 exec, -1
LW_6:
    ds_read_b32 v5, v3 offset:28
    ds_read_b128 v[40:43], v17
    ds_read_b128 v[44:47], v17 offset:16
    s_mov_b64 exec, s[60:61]
    ds_read_b128 v[200:203], v15 offset:0
    ds_read_b128 v[204:207], v15 offset:64
    ds_read_b128 v[208:211], v15 offset:128
    ds_read_b128 v[212:215], v15 offset:192
    s_mov_b64 exec, -1
    s_sub_u32 s70, s70, 1
    s_cbranch_scc1 L_EXIT
    s_waitcnt lgkmcnt(0)
    v_cmp_le_u32 vcc, 5, v5
    s_cbranch_vccz LW_6
    v_mfma_f32_16x16x32_bf16 v[56:59], v[200:203], v[104:107], 0
    v_mfma_f32_16x16x32_bf16 v[60:63], v[200:203], v[120:123], 0
    v_max3_f32 v6, v40, v42, v44
    v_max_f32 v6, v6, v46
    v_mfma_f32_16x16x32_bf16 v[56:59], v[204:207], v[108:111], v[56:59]
    v_sub_f32 v40, v40, v6
    v_sub_f32 v42, v42, v6
    v_mfma_f32_16x16x32_bf16 v[60:63], v[204:207], v[124:127], v[60:63]
    v_sub_f32 v44, v44, v6
    v_sub_f32 v46, v46, v6
    v_mfma_f32_16x16x32_bf16 v[56:59], v[208:211], v[112:115], v[56:59]
    v_exp_f32 v40, v40
    v_exp_f32 v42, v42
    v_mfma_f32_16x16x32_bf16 v[60:63], v[208:211], v[128:131], v[60:63]
    v_exp_f32 v44, v44
    v_exp_f32 v46, v46
    v_mfma_f32_16x16x32_bf16 v[56:59], v[212:215], v[116:119], v[56:59]
    v_mfma_f32_16x16x32_bf16 v[60:63], v[212:215], v[132:135], v[60:63]
    v_mul_f32 v7, v40, v41
    v_fmac_f32 v7, v42, v43
    v_fmac_f32 v7, v44, v45
    v_fmac_f32 v7, v46, v47
    v_rcp_f32 v7, v7
    s_nop 1
    v_mul_f32 v56, v56, v40
    v_mul_f32 v60, v60, v40
    v_fmac_f32 v56, v57, v42
    v_fmac_f32 v60, v61, v42
    v_fmac_f32 v56, v58, v44
    v_fmac_f32 v60, v62, v44
    v_fmac_f32 v56, v59, v46
    v_fmac_f32 v60, v63, v46
    v_mul_f32 v56, v56, v7
    v_mul_f32 v60, v60, v7
    v_perm_b32 v56, v60, v56, s29
    v_and_or_b32 v56, v56, s41, v220
    s_mov_b64 exec, 0xffff
    global_store_dword v18, v56, s[42:43]
    s_mov_b64 exec, -1
    v_mov_b32 v224, v56
    s_cmp_lt_u32 s5, 10
    s_cbranch_scc0 L_CPB
    s_cmp_eq_u32 s62, 0
    s_cbranch_scc1 L_WO2
L_WO3:
    s_mov_b32 s66, 0
L_WP:
    buffer_load_dwordx4 v[28:31], v19, s[44:47], s54 offen sc1
    s_waitcnt vmcnt(0)
    v_xor_b32 v28, v28, v8
    v_xor_b32 v29, v29, v9
    v_xor_b32 v30, v30, v10
    v_xor_b32 v31, v31, v11
    v_bitop3_b32 v5, v28, v29, v30 bitop3:0x80
    v_bitop3_b32 v5, v5, v31, s28 bitop3:0x80
    v_cmp_ne_u32 vcc, s28, v5
    s_cbranch_vccnz L_WPR
    s_mov_b64 exec, 1
    ds_add_u32 v3, v4 offset:52
    s_mov_b64 exec, -1
    v_mfma_f32_16x16x32_bf16 v[40:43], v[28:31], v[136:139], 0
    v_mfma_f32_16x16x32_bf16 v[44:47], v[28:31], v[140:143], 0
    v_mfma_f32_16x16x32_bf16 v[48:51], v[28:31], v[144:147], 0
    v_mfma_f32_16x16x32_bf16 v[52:55], v[28:31], v[148:151], 0
    v_mfma_f32_16x16x32_bf16 v[56:59], v[28:31], v[152:155], 0
    v_mfma_f32_16x16x32_bf16 v[60:63], v[28:31], v[156:159], 0
    v_mfma_f32_16x16x32_bf16 v[64:67], v[28:31], v[160:163], 0
    v_mfma_f32_16x16x32_bf16 v[68:71], v[28:31], v[164:167], 0
    v_mfma_f32_16x16x32_bf16 v[72:75], v[28:31], v[168:171], 0
    v_mfma_f32_16x16x32_bf16 v[76:79], v[28:31], v[172:175], 0
    v_mfma_f32_16x16x32_bf16 v[80:83], v[28:31], v[176:179], 0
    v_mfma_f32_16x16x32_bf16 v[84:87], v[28:31], v[180:183], 0
    v_mfma_f32_16x16x32_bf16 v[88:91], v[28:31], v[184:187], 0
    v_mfma_f32_16x16x32_bf16 v[92:95], v[28:31], v[188:191], 0
    v_mfma_f32_16x16x32_bf16 v[96:99], v[28:31], v[192:195], 0
    v_mfma_f32_16x16x32_bf16 v[100:103], v[28:31], v[196:199], 0
    v_add_f32 v40, v40, v45
    v_add_f32 v50, v50, v55
    v_add_f32 v40, v40, v50
    v_add_f32 v56, v56, v61
    v_add_f32 v66, v66, v71
    v_add_f32 v56, v56, v66
    v_add_f32 v72, v72, v77
    v_add_f32 v82, v82, v87
    v_add_f32 v72, v72, v82
    v_add_f32 v88, v88, v93
    v_add_f32 v98, v98, v103
    v_add_f32 v88, v88, v98
    v_permlane32_swap_b32 v40, v72
    s_nop 0
    v_permlane32_swap_b32 v56, v88
    v_add_f32 v40, v40, v72
    v_add_f32 v56, v56, v88
    s_nop 1
    v_permlane16_swap_b32 v40, v56
    v_add_f32 v40, v40, v56
    ds_write_b32 v20, v40
    s_mov_b64 exec, 1
    ds_add_u32 v3, v4 offset:32
    s_mov_b64 exec, -1
    s_cmp_eq_u32 s3, 0
    s_cbranch_scc0 L_CPW
LW_7:
    ds_read_b32 v5, v3 offset:32
    ds_read_b128 v[80:83], v21
    ds_read_b128 v[84:87], v21 offset:16
    s_sub_u32 s70, s70, 1
    s_cbranch_scc1 L_EXIT
    s_waitcnt lgkmcnt(0)
    v_cmp_le_u32 vcc, 4, v5
    s_cbranch_vccz LW_7
    v_add_f32 v80, v80, v81
    v_add_f32 v84, v84, v85
    v_add_f32 v82, v82, v83
    v_add_f32 v86, v86, v87
    v_add_f32 v80, v80, v82
    v_add_f32 v84, v84, v86
    v_cvt_pk_bf16_f32 v80, v80, v84
    v_min_u32 v80, -2, v80
    buffer_store_dword v80, v22, s[44:47], s55 offen sc1
    buffer_store_dword v80, v22, s[44:47], s56 offen sc1
    s_branch L_CPB
L_H0:
    s_sub_u32 s70, s70, 1
    s_cbranch_scc1 L_EXIT
    s_add_u32 s55, s55, 1
    s_and_b32 s8, s55, 31
    s_cselect_b32 s54, s52, s53
    buffer_load_dwordx4 v[72:75], v12, s[44:47], s54 offen sc1
    s_branch L_H1
L_WPR:
    s_sub_u32 s70, s70, 1
    s_cbranch_scc1 L_EXIT
    s_add_u32 s66, s66, 1
    s_mov_b32 s54, s64
    s_and_b32 s8, s66, 31
    s_cbranch_scc1 L_WP
    s_mov_b64 exec, 0xffff
    buffer_store_dword v224, v18, s[44:47], s63 offen sc1
    s_mov_b64 exec, -1
    s_mov_b32 s54, s65
    s_branch L_WP
L_CPW:
    s_sleep 32
L_CPB:
    s_mov_b64 exec, 0xffff
    buffer_store_dword v224, v18, s[44:47], s63 offen sc1
    s_mov_b64 exec, -1
    s_cmp_eq_u32 s2, 127
    s_cbranch_scc0 L_EXIT
    s_cmp_eq_u32 s3, 3
    s_cbranch_scc0 L_EXIT
    s_mov_b64 exec, 1
    v_mov_b32 v5, 131072
    global_store_dword v5, v223, s[42:43] sc1
    s_branch L_EXIT
L_STR:
    s_mov_b64 exec, vcc
    s_sleep 1
    global_load_dwordx4 v[28:31], v12, s[42:43] sc1
    s_sub_u32 s70, s70, 1
    s_cbranch_scc1 L_EXIT
    s_waitcnt vmcnt(0)
    v_xor_b32 v5, s40, v30
    v_xor_b32 v6, s57, v31
    v_or_b32 v5, v5, v6
    v_cmp_ne_u32 vcc, 0, v5
    s_cbranch_vccnz L_STR
    s_mov_b64 exec, -1
    s_sleep 2
    s_branch L_STD
L_WO2:
LW_8:
    ds_read_b32 v5, v3 offset:208
    s_sub_u32 s70, s70, 1
    s_cbranch_scc1 L_EXIT
    s_waitcnt lgkmcnt(0)
    v_cmp_le_u32 vcc, 2, v5
    s_cbranch_vccnz LK_9
    s_sleep 1
    s_branch LW_8
LK_9:
    ds_read_b64_tr_b16 v[136:137], v216 offset:0
    ds_read_b64_tr_b16 v[138:139], v216 offset:256
    ds_read_b64_tr_b16 v[140:141], v216 offset:512
    ds_read_b64_tr_b16 v[142:143], v216 offset:768
    ds_read_b64_tr_b16 v[144:145], v216 offset:1024
    ds_read_b64_tr_b16 v[146:147], v216 offset:1280
    ds_read_b64_tr_b16 v[148:149], v216 offset:1536
    ds_read_b64_tr_b16 v[150:151], v216 offset:1792
    ds_read_b64_tr_b16 v[152:153], v217 offset:0
    ds_read_b64_tr_b16 v[154:155], v217 offset:256
    ds_read_b64_tr_b16 v[156:157], v217 offset:512
    ds_read_b64_tr_b16 v[158:159], v217 offset:768
    ds_read_b64_tr_b16 v[160:161], v217 offset:1024
    ds_read_b64_tr_b16 v[162:163], v217 offset:1280
    ds_read_b64_tr_b16 v[164:165], v217 offset:1536
    ds_read_b64_tr_b16 v[166:167], v217 offset:1792
    ds_read_b64_tr_b16 v[168:169], v218 offset:0
    ds_read_b64_tr_b16 v[170:171], v218 offset:256
    ds_read_b64_tr_b16 v[172:173], v218 offset:512
    ds_read_b64_tr_b16 v[174:175], v218 offset:768
    ds_read_b64_tr_b16 v[176:177], v218 offset:1024
    ds_read_b64_tr_b16 v[178:179], v218 offset:1280
    ds_read_b64_tr_b16 v[180:181], v218 offset:1536
    ds_read_b64_tr_b16 v[182:183], v218 offset:1792
    ds_read_b64_tr_b16 v[184:185], v219 offset:0
    ds_read_b64_tr_b16 v[186:187], v219 offset:256
    ds_read_b64_tr_b16 v[188:189], v219 offset:512
    ds_read_b64_tr_b16 v[190:191], v219 offset:768
    ds_read_b64_tr_b16 v[192:193], v219 offset:1024
    ds_read_b64_tr_b16 v[194:195], v219 offset:1280
    ds_read_b64_tr_b16 v[196:197], v219 offset:1536
    ds_read_b64_tr_b16 v[198:199], v219 offset:1792
    s_waitcnt lgkmcnt(0)
    s_branch L_WO3
L_OR:
    s_sleep 1
    s_sub_u32 s70, s70, 1
    s_cbranch_scc1 L_EXIT
    s_nop 7
    buffer_load_dwordx4 v[40:43], v13, s[44:47], s52 offen offset:0 sc1
    buffer_load_dwordx4 v[44:47], v13, s[44:47], s52 offen offset:1024 sc1
    buffer_load_dwordx4 v[48:51], v13, s[44:47], s52 offen offset:2048 sc1
    buffer_load_dwordx4 v[52:55], v13, s[44:47], s52 offen offset:3072 sc1
    buffer_load_dwordx4 v[56:59], v13, s[44:47], s53 offen offset:0 sc1
    buffer_load_dwordx4 v[60:63], v13, s[44:47], s53 offen offset:1024 sc1
    buffer_load_dwordx4 v[64:67], v13, s[44:47], s53 offen offset:2048 sc1
    buffer_load_dwordx4 v[68:71], v13, s[44:47], s53 offen offset:3072 sc1
    s_branch L_OC
    .p2align 10
L_W4:
    s_cmp_ge_u32 s3, 6
    s_cbranch_scc1 L_WLD
    v_subrev_u32 v6, 16, v0
    v_cmp_gt_u32 vcc, 32, v6
    v_mov_b32 v5, 0xff800000
    s_nop 0
    v_cndmask_b32 v5, 0, v5, vcc
    v_lshl_add_u32 v6, v0, 2, v3
    ds_write_b32 v6, v5
    s_mul_i32 s8, s4, 135168
    s_add_u32 s8, s8, 6291456
    v_lshl_add_u32 v12, v0, 4, s8
    s_waitcnt lgkmcnt(0)
    s_load_dword s40, s[42:43], 131072
    s_lshl_b32 s9, s5, 8
    s_add_u32 s9, s9, s8
    v_lshl_add_u32 v5, v0, 7, s9
    s_mov_b64 exec, 3
    global_load_dword v50, v5, s[42:43] sc1
    s_mov_b64 exec, -1
    s_waitcnt lgkmcnt(0)
    s_add_u32 s40, s40, 0x11111111
    s_mov_b32 s41, 0xfffefffe
    s_mov_b32 s29, 0x07060302
    s_mov_b32 s28, 0x00010001
    s_mov_b32 s44, s42
    s_mov_b32 s45, s43
    s_mov_b32 s46, 268435456
    s_mov_b32 s47, 0x20000
    s_not_b32 s8, s40
    v_and_b32 v5, 3, v0
    v_lshlrev_b32 v5, 2, v5
    v_lshrrev_b32 v5, v5, s8
    v_lshrrev_b32 v6, 0, v5
    v_and_b32 v8, s28, v6
    v_lshrrev_b32 v6, 1, v5
    v_and_b32 v9, s28, v6
    v_lshrrev_b32 v6, 2, v5
    v_and_b32 v10, s28, v6
    v_lshrrev_b32 v6, 3, v5
    v_and_b32 v11, s28, v6
    s_lshl_b32 s8, s4, 2
    s_mul_i32 s9, s5, 270848
    s_add_u32 s8, s8, s9
    s_add_u32 s8, s8, 8454144
    v_mul_u32_u24 v37, 67712, v0
    v_add_u32 v37, s8, v37
    v_mov_b32 v39, s40
    s_barrier
LW_10:
    ds_read_b32 v5, v3 offset:48
    s_sub_u32 s70, s70, 1
    s_cbranch_scc1 L_EXIT
    s_waitcnt lgkmcnt(0)
    v_cmp_le_u32 vcc, 4, v5
    s_cbranch_vccnz LK_11
    s_sleep 1
    s_branch LW_10
LK_11:
LW_12:
    ds_read_b32 v5, v3 offset:200
    s_sub_u32 s70, s70, 1
    s_cbranch_scc1 L_EXIT
    s_waitcnt lgkmcnt(0)
    v_cmp_le_u32 vcc, 4, v5
    s_cbranch_vccz LW_12
    s_sleep 2
    s_mov_b64 exec, 15
    global_store_dword v37, v39, s[42:43] sc1
    s_mov_b64 exec, -1
    s_mov_b64 exec, 1
    ds_add_u32 v3, v4 offset:8
    s_mov_b64 exec, -1
    s_and_b32 s8, s2, 63
    s_lshl_b32 s8, s8, 7
    s_add_u32 s12, s8, 163840
    v_lshl_add_u32 v7, v0, 2, v3
LW_13:
    ds_read_b32 v5, v3 offset:204
    s_sub_u32 s70, s70, 1
    s_cbranch_scc1 L_EXIT
    s_waitcnt lgkmcnt(0)
    v_cmp_le_u32 vcc, 2, v5
    s_cbranch_vccnz LK_14
    s_sleep 8
    s_branch LW_13
LK_14:
    s_mov_b32 s13, 128
L_W42:
    s_load_dwordx4 s[20:23], s[42:43], s12 glc
    s_sub_u32 s13, s13, 1
    s_cselect_b32 s10, 15, 0
    s_waitcnt lgkmcnt(0)
    s_cmp_eq_u32 s20, s40
    s_cselect_b32 s11, 1, 0
    s_or_b32 s10, s10, s11
    s_cmp_eq_u32 s21, s40
    s_cselect_b32 s11, 2, 0
    s_or_b32 s10, s10, s11
    s_cmp_eq_u32 s22, s40
    s_cselect_b32 s11, 4, 0
    s_or_b32 s10, s10, s11
    s_cmp_eq_u32 s23, s40
    s_cselect_b32 s11, 8, 0
    s_or_b32 s10, s10, s11
    s_cbranch_scc0 L_W42
    s_mov_b32 exec_lo, s10
    s_mov_b32 exec_hi, 0
    ds_write_b32 v7, v4 offset:224
    s_cmp_eq_u32 s10, 15
    s_cbranch_scc0 L_W42
    s_mov_b64 exec, -1
    s_cmp_lt_u32 s5, 8
    s_cbranch_scc0 L_EXIT
    s_lshl_b32 s8, s4, 2
    s_lshl_b32 s9, s5, 10
    s_add_u32 s8, s8, s9
    s_add_u32 s8, s8, 180224
    v_lshl_add_u32 v12, v0, 7, s8
LW_15:
    ds_read_b32 v5, v3 offset:28
    s_sub_u32 s70, s70, 1
    s_cbranch_scc1 L_EXIT
    s_waitcnt lgkmcnt(0)
    v_cmp_le_u32 vcc, 5, v5
    s_cbranch_vccnz LK_16
    s_sleep 2
    s_branch LW_15
LK_16:
LW_17:
    ds_read_b32 v5, v3 offset:52
    s_sub_u32 s70, s70, 1
    s_cbranch_scc1 L_EXIT
    s_waitcnt lgkmcnt(0)
    v_cmp_le_u32 vcc, 4, v5
    s_cbranch_vccz LW_17
    s_mov_b64 exec, 0xff
    global_store_dword v12, v39, s[42:43] sc1
    s_branch L_EXIT
    .p2align 10
L_W5:
    v_mul_u32_u24 v6, 20, v0
    s_waitcnt lgkmcnt(0)
    global_load_dwordx4 v[18:21], v6, s[16:17]
    global_load_dword v22, v6, s[16:17] offset:16
    s_load_dword s40, s[42:43], 131072
    v_mov_b32 v17, 0x3f803f80
    v_mov_b32 v32, 0
    v_mov_b32 v33, 0
    v_lshlrev_b32 v12, 4, v0
    v_add_u32 v12, 135680, v12
    s_waitcnt lgkmcnt(0)
    s_add_u32 s40, s40, 0x11111111
    s_mov_b32 s41, 0xfffefffe
    s_mov_b32 s29, 0x07060302
    s_mov_b32 s28, 0x00010001
    s_mov_b32 s44, s42
    s_mov_b32 s45, s43
    s_mov_b32 s46, 268435456
    s_mov_b32 s47, 0x20000
    s_not_b32 s8, s40
    v_and_b32 v5, 3, v0
    v_lshlrev_b32 v5, 2, v5
    v_lshrrev_b32 v5, v5, s8
    v_lshrrev_b32 v6, 0, v5
    v_and_b32 v8, s28, v6
    v_lshrrev_b32 v6, 1, v5
    v_and_b32 v9, s28, v6
    v_lshrrev_b32 v6, 2, v5
    v_and_b32 v10, s28, v6
    v_lshrrev_b32 v6, 3, v5
    v_and_b32 v11, s28, v6
    s_mul_i32 s8, s4, 135168
    s_lshl_b32 s9, s5, 8
    s_add_u32 s8, s8, s9
    s_add_u32 s8, s8, 6291456
    v_and_b32 v5, 1, v2
    v_lshlrev_b32 v5, 1, v5
    v_lshl_add_u32 v5, v1, 2, v5
    v_lshrrev_b32 v6, 1, v2
    v_add_u32 v5, v5, v6
    v_lshl_add_u32 v34, v5, 2, s8
    v_and_b32 v5, 15, v5
    v_lshrrev_b32 v5, v5, s40
    v_and_b32 v35, s28, v5
    s_waitcnt vmcnt(0)
    v_dot2c_f32_bf16 v32, v18, v17
    v_dot2c_f32_bf16 v33, v18, v18
    v_dot2c_f32_bf16 v32, v19, v17
    v_dot2c_f32_bf16 v33, v19, v19
    v_dot2c_f32_bf16 v32, v20, v17
    v_dot2c_f32_bf16 v33, v20, v20
    v_dot2c_f32_bf16 v32, v21, v17
    v_dot2c_f32_bf16 v33, v21, v21
    v_dot2c_f32_bf16 v32, v22, v17
    v_dot2c_f32_bf16 v33, v22, v22
    s_nop 2
    v_permlane32_swap_b32 v32, v33
    v_add_f32 v32, v32, v33
    v_mov_b32 v33, v32
    s_nop 1
    v_permlane16_swap_b32 v32, v33
    v_add_f32 v32, v32, v33
    s_nop 1
    v_add_f32_dpp v32, v32, v32 quad_perm:[1,0,3,2] row_mask:0xf bank_mask:0xf
    s_nop 1
    v_add_f32_dpp v32, v32, v32 quad_perm:[2,3,0,1] row_mask:0xf bank_mask:0xf
    s_nop 1
    v_add_f32_dpp v32, v32, v32 row_half_mirror row_mask:0xf bank_mask:0xf
    s_nop 1
    v_add_f32_dpp v32, v32, v32 row_mirror row_mask:0xf bank_mask:0xf
    v_mul_f32 v32, 0x3acccccd, v32
    v_mov_b32 v33, v32
    s_nop 1
    v_permlane32_swap_b32 v32, v33
    v_fma_f32 v33, -v32, v32, v33
    v_max_f32 v33, 0, v33
    v_cvt_pk_bf16_f32 v5, v33, v33
    v_and_b32 v33, 0xffff0000, v5
    v_add_f32 v33, 0x3727c5ac, v33
    v_cvt_pk_bf16_f32 v5, v33, v33
    v_and_b32 v33, 0xffff0000, v5
    v_sqrt_f32 v33, v33
    v_cvt_pk_bf16_f32 v5, v32, v32
    v_and_b32 v32, 0xffff0000, v5
    v_cvt_pk_bf16_f32 v5, v33, v33
    v_and_b32 v33, 0xffff0000, v5
    v_rcp_f32 v33, v33
    s_nop 0
    v_mul_f32 v33, 0x3e0293ee, v33
    v_cmp_gt_u32 vcc, 32, v0
    v_mul_f32 v32, -v32, v33
    s_nop 0
    v_cndmask_b32 v32, v32, v33, vcc
    s_barrier
    ds_read_b128 v[40:43], v12 offset:0
    ds_read_b128 v[44:47], v12 offset:1024
    ds_read_b128 v[48:51], v12 offset:2048
    ds_read_b128 v[52:55], v12 offset:3072
    s_waitcnt lgkmcnt(0)
    v_add_f32 v40, v40, v44
    v_add_f32 v48, v48, v52
    v_add_f32 v41, v41, v45
    v_add_f32 v49, v49, v53
    v_add_f32 v42, v42, v46
    v_add_f32 v50, v50, v54
    v_add_f32 v43, v43, v47
    v_add_f32 v51, v51, v55
    v_add_f32 v40, v40, v48
    v_add_f32 v41, v41, v49
    v_add_f32 v42, v42, v50
    v_add_f32 v43, v43, v51
    v_mul_f32 v40, v40, v32
    v_mul_f32 v41, v41, v32
    v_mul_f32 v42, v42, v32
    v_mul_f32 v43, v43, v32
    s_nop 0
    v_permlane32_swap_b32 v40, v42
    v_permlane32_swap_b32 v41, v43
    v_add_f32 v40, v40, v42
    v_add_f32 v41, v41, v43
    v_perm_b32 v40, v41, v40, s29
    v_and_or_b32 v40, v40, s41, v35
    global_store_dword v34, v40, s[42:43]
    s_lshl_b32 s8, s6, 11
    s_lshl_b32 s9, s7, 7
    s_add_u32 s8, s8, s9
    s_add_u32 s8, s8, 393216
    v_lshrrev_b32 v5, 3, v0
    v_lshlrev_b32 v5, 9, v5
    v_and_b32 v6, 7, v0
    v_lshl_add_u32 v5, v6, 4, v5
    v_add_u32 v13, s8, v5
    s_mov_b32 s9, 24
L_W51:
    s_sleep 8
    ds_read_b32 v5, v3 offset:204
    s_sub_u32 s9, s9, 1
    s_cbranch_scc1 L_W52
    s_waitcnt lgkmcnt(0)
    v_cmp_le_u32 vcc, 2, v5
    s_cbranch_vccz L_W51
L_W52:
    v_add_u32 v34, 0x8000, v34
    global_store_dword v34, v40, s[42:43] sc1
    s_mov_b64 exec, 0x01010101
    global_load_dword v50, v13, s[42:43] sc1
    s_waitcnt vmcnt(0)
    s_mov_b64 exec, 1
    ds_add_u32 v3, v4 offset:28
    s_mov_b64 exec, -1
    s_branch L_EXIT
    .p2align 10
L_WLD:
    s_sub_u32 s10, s3, 6
    s_lshl_b32 s11, s10, 10
    v_lshlrev_b32 v5, 2, v2
    v_xor_b32 v5, v5, v1
    v_xor_b32 v5, s10, v5
    v_xor_b32 v6, 0, v5
    v_lshlrev_b32 v6, 4, v6
    v_lshl_add_u32 v8, v2, 13, v6
    v_xor_b32 v6, 2, v5
    v_lshlrev_b32 v6, 4, v6
    v_lshl_add_u32 v9, v2, 13, v6
    v_lshrrev_b32 v5, 3, v0
    v_mul_u32_u24 v5, 1280, v5
    v_and_b32 v6, 7, v0
    v_xor_b32 v7, 0, v6
    v_lshl_add_u32 v12, v7, 4, v5
    v_xor_b32 v7, 2, v6
    v_lshl_add_u32 v13, v7, 4, v5
    v_xor_b32 v7, 4, v6
    v_lshl_add_u32 v14, v7, 4, v5
    v_xor_b32 v7, 6, v6
    v_lshl_add_u32 v15, v7, 4, v5
    s_lshl_b32 s12, s7, 20
    s_lshl_b32 s9, s71, 8
    s_add_u32 s12, s12, s9
    s_lshl_b32 s9, s10, 15
    s_add_u32 s12, s12, s9
    s_lshl_b32 s13, s5, 7
    s_mul_i32 s9, s10, 8*1280
    s_add_u32 s13, s13, s9
    s_xor_b32 s8, s4, 0
    s_mul_i32 s8, s8, 128*1280
    s_add_u32 s52, s13, s8
    s_xor_b32 s8, s4, 9
    s_mul_i32 s8, s8, 128*1280
    s_add_u32 s53, s13, s8
    s_xor_b32 s8, s4, 18
    s_mul_i32 s8, s8, 128*1280
    s_add_u32 s54, s13, s8
    s_xor_b32 s8, s4, 27
    s_mul_i32 s8, s8, 128*1280
    s_add_u32 s55, s13, s8
    s_waitcnt lgkmcnt(0)
    s_barrier
    v_lshlrev_b32 v5, 4, v1
    v_lshl_add_u32 v16, v2, 10, v5
    s_lshl_b32 s8, s4, 4
    s_add_u32 s8, s8, s5
    s_lshl_b32 s8, s8, 17
    s_lshl_b32 s9, s10, 12
    s_add_u32 s15, s8, s9
    s_and_b32 s8, s5, 3
    s_xor_b32 s8, s8, 0
    s_lshl_b32 s8, s8, 8
    s_add_u32 s56, s15, s8
    s_and_b32 s8, s5, 3
    s_xor_b32 s8, s8, 1
    s_lshl_b32 s8, s8, 8
    s_add_u32 s57, s15, s8
    s_and_b32 s8, s5, 3
    s_xor_b32 s8, s8, 2
    s_lshl_b32 s8, s8, 8
    s_add_u32 s58, s15, s8
    s_and_b32 s8, s5, 3
    s_xor_b32 s8, s8, 3
    s_lshl_b32 s8, s8, 8
    s_add_u32 s59, s15, s8
    s_mov_b32 s48, s18
    s_mov_b32 s49, s19
    s_mov_b32 s50, 16777216
    s_mov_b32 s51, 0x20000
LW_18:
    ds_read_b32 v5, v3 offset:8
    s_sub_u32 s70, s70, 1
    s_cbranch_scc1 L_EXIT
    s_waitcnt lgkmcnt(0)
    v_cmp_le_u32 vcc, 5, v5
    s_cbranch_vccnz LK_19
    s_sleep 2
    s_branch LW_18
LK_19:
    s_add_u32 m0, s11, 81920
    s_add_u32 s14, s58, 16384
    buffer_load_dwordx4 v16, s[48:51], s14 offen  lds
    s_add_u32 m0, s11, 83968
    s_add_u32 s14, s59, 49152
    buffer_load_dwordx4 v16, s[48:51], s14 offen  lds
    s_add_u32 m0, s11, 86016
    s_add_u32 s14, s56, 81920
    buffer_load_dwordx4 v16, s[48:51], s14 offen  lds
    s_add_u32 m0, s11, 88064
    s_add_u32 s14, s57, 114688
    buffer_load_dwordx4 v16, s[48:51], s14 offen  lds
    s_add_u32 m0, s11, 90112
    s_add_u32 s14, s58, 24576
    buffer_load_dwordx4 v16, s[48:51], s14 offen  lds
    s_add_u32 m0, s11, 92160
    s_add_u32 s14, s59, 57344
    buffer_load_dwordx4 v16, s[48:51], s14 offen  lds
    s_add_u32 m0, s11, 94208
    s_add_u32 s14, s56, 90112
    buffer_load_dwordx4 v16, s[48:51], s14 offen  lds
    s_add_u32 m0, s11, 96256
    s_add_u32 s14, s57, 122880
    buffer_load_dwordx4 v16, s[48:51], s14 offen  lds
    s_add_u32 m0, s11, 98304
    s_add_u32 s14, s59, 0
    buffer_load_dwordx4 v16, s[48:51], s14 offen  lds
    s_add_u32 m0, s11, 100352
    s_add_u32 s14, s58, 32768
    buffer_load_dwordx4 v16, s[48:51], s14 offen  lds
    s_add_u32 m0, s11, 102400
    s_add_u32 s14, s57, 65536
    buffer_load_dwordx4 v16, s[48:51], s14 offen  lds
    s_add_u32 m0, s11, 104448
    s_add_u32 s14, s56, 98304
    buffer_load_dwordx4 v16, s[48:51], s14 offen  lds
    s_waitcnt vmcnt(11)
    s_add_u32 m0, s11, 106496
    s_add_u32 s14, s59, 8192
    buffer_load_dwordx4 v16, s[48:51], s14 offen  lds
    s_waitcnt vmcnt(11)
    s_add_u32 m0, s11, 108544
    s_add_u32 s14, s58, 40960
    buffer_load_dwordx4 v16, s[48:51], s14 offen  lds
    s_waitcnt vmcnt(11)
    s_add_u32 m0, s11, 110592
    s_add_u32 s14, s57, 73728
    buffer_load_dwordx4 v16, s[48:51], s14 offen  lds
    s_waitcnt vmcnt(11)
    s_add_u32 m0, s11, 112640
    s_add_u32 s14, s56, 106496
    buffer_load_dwordx4 v16, s[48:51], s14 offen  lds
    s_waitcnt vmcnt(11)
    s_add_u32 m0, s11, 114688
    s_add_u32 s14, s59, 16384
    buffer_load_dwordx4 v16, s[48:51], s14 offen  lds
    s_waitcnt vmcnt(11)
    s_add_u32 m0, s11, 116736
    s_add_u32 s14, s58, 49152
    buffer_load_dwordx4 v16, s[48:51], s14 offen  lds
    s_waitcnt vmcnt(11)
    s_add_u32 m0, s11, 118784
    s_add_u32 s14, s57, 81920
    buffer_load_dwordx4 v16, s[48:51], s14 offen  lds
    s_waitcnt vmcnt(11)
    s_add_u32 m0, s11, 120832
    s_add_u32 s14, s56, 114688
    buffer_load_dwordx4 v16, s[48:51], s14 offen  lds
    s_waitcnt vmcnt(11)
    s_add_u32 m0, s11, 122880
    s_add_u32 s14, s59, 24576
    buffer_load_dwordx4 v16, s[48:51], s14 offen  lds
    s_waitcnt vmcnt(11)
    s_add_u32 m0, s11, 124928
    s_add_u32 s14, s58, 57344
    buffer_load_dwordx4 v16, s[48:51], s14 offen  lds
    s_waitcnt vmcnt(11)
    s_add_u32 m0, s11, 126976
    s_add_u32 s14, s57, 90112
    buffer_load_dwordx4 v16, s[48:51], s14 offen  lds
    s_waitcnt vmcnt(11)
    s_add_u32 m0, s11, 129024
    s_add_u32 s14, s56, 122880
    buffer_load_dwordx4 v16, s[48:51], s14 offen  lds
    s_waitcnt vmcnt(11)
    s_mov_b32 s48, s24
    s_mov_b32 s49, s25
    s_mov_b32 s50, 4194304
    s_mov_b32 s51, 0x20000
    s_add_u32 m0, s11, 32768
    s_add_u32 s14, s12, 0
    buffer_load_dwordx4 v8, s[48:51], s14 offen nt lds
    s_add_u32 m0, s11, 34816
    s_add_u32 s14, s12, 65536
    buffer_load_dwordx4 v9, s[48:51], s14 offen nt lds
    s_add_u32 m0, s11, 36864
    s_add_u32 s14, s12, 131072
    buffer_load_dwordx4 v8, s[48:51], s14 offen nt lds
    s_add_u32 m0, s11, 38912
    s_add_u32 s14, s12, 196608
    buffer_load_dwordx4 v9, s[48:51], s14 offen nt lds
    s_add_u32 m0, s11, 40960
    s_add_u32 s14, s12, 262144
    buffer_load_dwordx4 v8, s[48:51], s14 offen nt lds
    s_waitcnt vmcnt(15)
    s_add_u32 m0, s11, 43008
    s_add_u32 s14, s12, 327680
    buffer_load_dwordx4 v9, s[48:51], s14 offen nt lds
    s_waitcnt vmcnt(15)
    s_add_u32 m0, s11, 45056
    s_add_u32 s14, s12, 393216
    buffer_load_dwordx4 v8, s[48:51], s14 offen nt lds
    s_waitcnt vmcnt(15)
    s_add_u32 m0, s11, 47104
    s_add_u32 s14, s12, 458752
    buffer_load_dwordx4 v9, s[48:51], s14 offen nt lds
    s_waitcnt vmcnt(15)
    s_add_u32 m0, s11, 49152
    s_add_u32 s14, s12, 524288
    buffer_load_dwordx4 v8, s[48:51], s14 offen nt lds
    s_waitcnt vmcnt(15)
    s_add_u32 m0, s11, 51200
    s_add_u32 s14, s12, 589824
    buffer_load_dwordx4 v9, s[48:51], s14 offen nt lds
    s_waitcnt vmcnt(15)
    s_add_u32 m0, s11, 53248
    s_add_u32 s14, s12, 655360
    buffer_load_dwordx4 v8, s[48:51], s14 offen nt lds
    s_waitcnt vmcnt(15)
    s_add_u32 m0, s11, 55296
    s_add_u32 s14, s12, 720896
    buffer_load_dwordx4 v9, s[48:51], s14 offen nt lds
    s_waitcnt vmcnt(15)
    s_add_u32 m0, s11, 57344
    s_add_u32 s14, s12, 786432
    buffer_load_dwordx4 v8, s[48:51], s14 offen nt lds
    s_waitcnt vmcnt(15)
    s_add_u32 m0, s11, 59392
    s_add_u32 s14, s12, 851968
    buffer_load_dwordx4 v9, s[48:51], s14 offen nt lds
    s_waitcnt vmcnt(15)
    s_add_u32 m0, s11, 61440
    s_add_u32 s14, s12, 917504
    buffer_load_dwordx4 v8, s[48:51], s14 offen nt lds
    s_waitcnt vmcnt(15)
    s_add_u32 m0, s11, 63488
    s_add_u32 s14, s12, 983040
    buffer_load_dwordx4 v9, s[48:51], s14 offen nt lds
    s_waitcnt vmcnt(15)
    s_cmp_lt_u32 s5, 10
    s_cbranch_scc1 L_WLD2
    s_sub_u32 s8, s5, 10
    s_lshl_b32 s8, s8, 1
    s_add_u32 s8, s8, s10
    s_add_u32 s8, s8, 4
    s_lshr_b32 s9, s8, 3
    s_and_b32 s8, s8, 7
    s_add_u32 s9, s9, 2
    s_mul_i32 s9, s9, 9
    s_xor_b32 s9, s9, s4
    s_xor_b32 s9, s9, 4
    s_mul_i32 s9, s9, 128*1280
    s_mul_i32 s8, s8, 20480
    s_add_u32 s13, s8, s9
    v_lshlrev_b32 v17, 4, v0
    s_mov_b32 s48, s26
    s_mov_b32 s49, s27
    s_mov_b32 s50, 5242880
    s_mov_b32 s51, 0x20000
    s_add_u32 m0, s11, 65536
    s_add_u32 s14, s13, 0
    buffer_load_dwordx4 v17, s[48:51], s14 offen lds
    s_waitcnt vmcnt(15)
    s_add_u32 m0, s11, 67584
    s_add_u32 s14, s13, 1024
    buffer_load_dwordx4 v17, s[48:51], s14 offen lds
    s_waitcnt vmcnt(15)
    s_add_u32 m0, s11, 69632
    s_add_u32 s14, s13, 2048
    buffer_load_dwordx4 v17, s[48:51], s14 offen lds
    s_waitcnt vmcnt(15)
    s_add_u32 m0, s11, 71680
    s_add_u32 s14, s13, 3072
    buffer_load_dwordx4 v17, s[48:51], s14 offen lds
    s_waitcnt vmcnt(15)
    s_add_u32 m0, s11, 73728
    s_add_u32 s14, s13, 4096
    buffer_load_dwordx4 v17, s[48:51], s14 offen lds
    s_waitcnt vmcnt(15)
    s_add_u32 m0, s11, 75776
    s_add_u32 s14, s13, 5120
    buffer_load_dwordx4 v17, s[48:51], s14 offen lds
    s_waitcnt vmcnt(15)
    s_add_u32 m0, s11, 77824
    s_add_u32 s14, s13, 6144
    buffer_load_dwordx4 v17, s[48:51], s14 offen lds
    s_waitcnt vmcnt(15)
    s_add_u32 m0, s11, 79872
    s_add_u32 s14, s13, 7168
    buffer_load_dwordx4 v17, s[48:51], s14 offen lds
    s_waitcnt vmcnt(15)
    s_add_u32 m0, s11, 81920
    s_add_u32 s14, s13, 8192
    buffer_load_dwordx4 v17, s[48:51], s14 offen lds
    s_waitcnt vmcnt(15)
    s_add_u32 m0, s11, 83968
    s_add_u32 s14, s13, 9216
    buffer_load_dwordx4 v17, s[48:51], s14 offen lds
    s_waitcnt vmcnt(15)
    s_add_u32 m0, s11, 86016
    s_add_u32 s14, s13, 10240
    buffer_load_dwordx4 v17, s[48:51], s14 offen lds
    s_waitcnt vmcnt(15)
    s_add_u32 m0, s11, 88064
    s_add_u32 s14, s13, 11264
    buffer_load_dwordx4 v17, s[48:51], s14 offen lds
    s_waitcnt vmcnt(15)
    s_add_u32 m0, s11, 90112
    s_add_u32 s14, s13, 12288
    buffer_load_dwordx4 v17, s[48:51], s14 offen lds
    s_waitcnt vmcnt(15)
    s_add_u32 m0, s11, 92160
    s_add_u32 s14, s13, 13312
    buffer_load_dwordx4 v17, s[48:51], s14 offen lds
    s_waitcnt vmcnt(15)
    s_add_u32 m0, s11, 94208
    s_add_u32 s14, s13, 14336
    buffer_load_dwordx4 v17, s[48:51], s14 offen lds
    s_waitcnt vmcnt(15)
    s_mov_b64 exec, 1
    ds_add_u32 v3, v4 offset:204
    s_mov_b64 exec, -1
    s_add_u32 m0, s11, 96256
    s_add_u32 s14, s13, 15360
    buffer_load_dwordx4 v17, s[48:51], s14 offen lds
    s_waitcnt vmcnt(15)
    s_add_u32 m0, s11, 98304
    s_add_u32 s14, s13, 16384
    buffer_load_dwordx4 v17, s[48:51], s14 offen lds
    s_waitcnt vmcnt(15)
    s_add_u32 m0, s11, 100352
    s_add_u32 s14, s13, 17408
    buffer_load_dwordx4 v17, s[48:51], s14 offen lds
    s_waitcnt vmcnt(15)
    s_add_u32 m0, s11, 102400
    s_add_u32 s14, s13, 18432
    buffer_load_dwordx4 v17, s[48:51], s14 offen lds
    s_waitcnt vmcnt(15)
    s_add_u32 m0, s11, 104448
    s_add_u32 s14, s13, 19456
    buffer_load_dwordx4 v17, s[48:51], s14 offen lds
    s_waitcnt vmcnt(15)
    s_branch L_EXIT
L_WLD2:
    s_mov_b32 s48, s26
    s_mov_b32 s49, s27
    s_mov_b32 s50, 5242880
    s_mov_b32 s51, 0x20000
    s_add_u32 m0, s11, 65536
    s_add_u32 s14, s52, 0
    buffer_load_dwordx4 v12, s[48:51], s14 offen nt lds
    s_waitcnt vmcnt(15)
    s_add_u32 m0, s11, 67584
    s_add_u32 s14, s52, 20480
    buffer_load_dwordx4 v13, s[48:51], s14 offen nt lds
    s_waitcnt vmcnt(15)
    s_add_u32 m0, s11, 69632
    s_add_u32 s14, s52, 40960
    buffer_load_dwordx4 v14, s[48:51], s14 offen nt lds
    s_waitcnt vmcnt(15)
    s_add_u32 m0, s11, 71680
    s_add_u32 s14, s52, 61440
    buffer_load_dwordx4 v15, s[48:51], s14 offen nt lds
    s_waitcnt vmcnt(15)
    s_add_u32 m0, s11, 73728
    s_add_u32 s14, s52, 81920
    buffer_load_dwordx4 v12, s[48:51], s14 offen nt lds
    s_waitcnt vmcnt(15)
    s_add_u32 m0, s11, 75776
    s_add_u32 s14, s52, 102400
    buffer_load_dwordx4 v13, s[48:51], s14 offen nt lds
    s_waitcnt vmcnt(15)
    s_add_u32 m0, s11, 77824
    s_add_u32 s14, s52, 122880
    buffer_load_dwordx4 v14, s[48:51], s14 offen nt lds
    s_waitcnt vmcnt(15)
    s_add_u32 m0, s11, 79872
    s_add_u32 s14, s52, 143360
    buffer_load_dwordx4 v15, s[48:51], s14 offen nt lds
    s_waitcnt vmcnt(15)
    s_add_u32 m0, s11, 81920
    s_add_u32 s14, s53, 0
    buffer_load_dwordx4 v12, s[48:51], s14 offen nt lds
    s_waitcnt vmcnt(15)
    s_add_u32 m0, s11, 83968
    s_add_u32 s14, s53, 20480
    buffer_load_dwordx4 v13, s[48:51], s14 offen nt lds
    s_waitcnt vmcnt(15)
    s_add_u32 m0, s11, 86016
    s_add_u32 s14, s53, 40960
    buffer_load_dwordx4 v14, s[48:51], s14 offen nt lds
    s_waitcnt vmcnt(15)
    s_add_u32 m0, s11, 88064
    s_add_u32 s14, s53, 61440
    buffer_load_dwordx4 v15, s[48:51], s14 offen nt lds
    s_waitcnt vmcnt(15)
    s_add_u32 m0, s11, 90112
    s_add_u32 s14, s53, 81920
    buffer_load_dwordx4 v12, s[48:51], s14 offen nt lds
    s_waitcnt vmcnt(15)
    s_add_u32 m0, s11, 92160
    s_add_u32 s14, s53, 102400
    buffer_load_dwordx4 v13, s[48:51], s14 offen nt lds
    s_waitcnt vmcnt(15)
    s_add_u32 m0, s11, 94208
    s_add_u32 s14, s53, 122880
    buffer_load_dwordx4 v14, s[48:51], s14 offen nt lds
    s_waitcnt vmcnt(15)
    s_mov_b64 exec, 1
    ds_add_u32 v3, v4 offset:204
    s_mov_b64 exec, -1
    s_add_u32 m0, s11, 96256
    s_add_u32 s14, s53, 143360
    buffer_load_dwordx4 v15, s[48:51], s14 offen nt lds
    s_waitcnt vmcnt(15)
    s_add_u32 m0, s11, 98304
    s_add_u32 s14, s54, 0
    buffer_load_dwordx4 v12, s[48:51], s14 offen nt lds
    s_waitcnt vmcnt(15)
    s_add_u32 m0, s11, 100352
    s_add_u32 s14, s54, 20480
    buffer_load_dwordx4 v13, s[48:51], s14 offen nt lds
    s_waitcnt vmcnt(15)
    s_add_u32 m0, s11, 102400
    s_add_u32 s14, s54, 40960
    buffer_load_dwordx4 v14, s[48:51], s14 offen nt lds
    s_waitcnt vmcnt(15)
    s_add_u32 m0, s11, 104448
    s_add_u32 s14, s54, 61440
    buffer_load_dwordx4 v15, s[48:51], s14 offen nt lds
    s_waitcnt vmcnt(15)
    s_add_u32 m0, s11, 106496
    s_add_u32 s14, s54, 81920
    buffer_load_dwordx4 v12, s[48:51], s14 offen  lds
    s_waitcnt vmcnt(15)
    s_add_u32 m0, s11, 108544
    s_add_u32 s14, s54, 102400
    buffer_load_dwordx4 v13, s[48:51], s14 offen  lds
    s_waitcnt vmcnt(15)
    s_add_u32 m0, s11, 110592
    s_add_u32 s14, s54, 122880
    buffer_load_dwordx4 v14, s[48:51], s14 offen  lds
    s_waitcnt vmcnt(15)
    s_add_u32 m0, s11, 112640
    s_add_u32 s14, s54, 143360
    buffer_load_dwordx4 v15, s[48:51], s14 offen  lds
    s_waitcnt vmcnt(15)
    s_add_u32 m0, s11, 114688
    s_add_u32 s14, s55, 0
    buffer_load_dwordx4 v12, s[48:51], s14 offen  lds
    s_waitcnt vmcnt(15)
    s_add_u32 m0, s11, 116736
    s_add_u32 s14, s55, 20480
    buffer_load_dwordx4 v13, s[48:51], s14 offen  lds
    s_waitcnt vmcnt(15)
    s_add_u32 m0, s11, 118784
    s_add_u32 s14, s55, 40960
    buffer_load_dwordx4 v14, s[48:51], s14 offen  lds
    s_waitcnt vmcnt(15)
    s_add_u32 m0, s11, 120832
    s_add_u32 s14, s55, 61440
    buffer_load_dwordx4 v15, s[48:51], s14 offen  lds
    s_waitcnt vmcnt(15)
    s_add_u32 m0, s11, 122880
    s_add_u32 s14, s55, 81920
    buffer_load_dwordx4 v12, s[48:51], s14 offen  lds
    s_waitcnt vmcnt(15)
    s_add_u32 m0, s11, 124928
    s_add_u32 s14, s55, 102400
    buffer_load_dwordx4 v13, s[48:51], s14 offen  lds
    s_waitcnt vmcnt(15)
    s_add_u32 m0, s11, 126976
    s_add_u32 s14, s55, 122880
    buffer_load_dwordx4 v14, s[48:51], s14 offen  lds
    s_waitcnt vmcnt(15)
    s_add_u32 m0, s11, 129024
    s_add_u32 s14, s55, 143360
    buffer_load_dwordx4 v15, s[48:51], s14 offen  lds
    s_waitcnt vmcnt(15)
    s_waitcnt vmcnt(0)
    s_mov_b64 exec, 1
    ds_add_u32 v3, v4 offset:208
    s_mov_b64 exec, -1
    s_branch L_EXIT
    .p2align 10
L_A:
    s_sub_u32 s6, s5, 16
    s_lshl_b32 s7, s4, 4
    s_add_u32 s7, s7, s6
    s_lshr_b32 s9, s6, 1
    s_lshl_b32 s9, s9, 3
    s_add_u32 s71, s9, s4
    s_and_b32 s8, s6, 1
    s_lshl_b32 s15, s71, 1
    s_add_u32 s15, s15, s8
    s_cmp_lt_u32 s3, 5
    s_cbranch_scc1 L_A2
    s_cmp_eq_u32 s3, 5
    s_cbranch_scc0 L_A0
    s_getpc_b64 s[8:9]
PC_20:
    s_sub_u32 s8, s8, PC_20-sequential_preLN__compressed_kv_cla__dense_activation_squared_relu__decode_kernel
    s_subb_u32 s9, s9, 0
    v_lshl_add_u32 v5, v0, 4, s6
    v_lshlrev_b32 v5, 7, v5
    v_min_u32 v5, L_CODE_END-sequential_preLN__compressed_kv_cla__dense_activation_squared_relu__decode_kernel-4, v5
    s_mov_b64 exec, 0xfffff
    global_load_dword v240, v5, s[8:9]
    s_mov_b64 exec, -1
    s_branch L_A1
L_A0:
    s_sub_u32 s10, s3, 6
    s_lshl_b32 s11, s10, 10
    v_lshlrev_b32 v5, 2, v2
    v_xor_b32 v5, v5, v1
    v_xor_b32 v5, s10, v5
    v_xor_b32 v6, 0, v5
    v_lshlrev_b32 v6, 4, v6
    v_lshl_add_u32 v8, v2, 10, v6
    v_xor_b32 v6, 2, v5
    v_lshlrev_b32 v6, 4, v6
    v_lshl_add_u32 v9, v2, 10, v6
    s_lshl_b32 s13, s7, 17
    s_lshl_b32 s9, s10, 12
    s_add_u32 s13, s13, s9
    s_and_b32 s8, s6, 3
    s_xor_b32 s8, s8, 0
    s_lshl_b32 s8, s8, 8
    s_add_u32 s52, s13, s8
    s_and_b32 s8, s6, 3
    s_xor_b32 s8, s8, 1
    s_lshl_b32 s8, s8, 8
    s_add_u32 s53, s13, s8
    s_and_b32 s8, s6, 3
    s_xor_b32 s8, s8, 2
    s_lshl_b32 s8, s8, 8
    s_add_u32 s54, s13, s8
    s_and_b32 s8, s6, 3
    s_xor_b32 s8, s8, 3
    s_lshl_b32 s8, s8, 8
    s_add_u32 s55, s13, s8
    v_lshlrev_b32 v18, 4, v0
    s_add_u32 s8, s11, 129024
    v_add_u32 v19, s8, v18
    s_waitcnt lgkmcnt(0)
    s_mov_b32 s48, s18
    s_mov_b32 s49, s19
    s_mov_b32 s50, 16777216
    s_mov_b32 s51, 0x20000
    s_add_u32 m0, s11, 0
    s_xor_b32 s14, s52, 0
    buffer_load_dwordx4 v8, s[48:51], s14 offen nt lds
    s_add_u32 m0, s11, 40960
    s_xor_b32 s14, s53, 32768
    buffer_load_dwordx4 v8, s[48:51], s14 offen nt lds
    s_lshl_b32 s8, s10, 6
    v_add_u32 v20, s8, v0
    v_add_u32 v5, 0, v20
    v_mul_u32_u24 v6, 52429, v5
    v_lshrrev_b32 v6, 21, v6
    v_and_b32 v6, 6, v6
    v_xor_b32 v5, v5, v6
    v_lshlrev_b32 v40, 4, v5
    v_xor_b32 v45, 0x80, v40
    v_add_u32 v5, 128, v20
    v_mul_u32_u24 v6, 52429, v5
    v_lshrrev_b32 v6, 21, v6
    v_and_b32 v6, 6, v6
    v_xor_b32 v5, v5, v6
    v_lshlrev_b32 v41, 4, v5
    v_xor_b32 v46, 0x80, v41
    v_add_u32 v5, 256, v20
    v_mul_u32_u24 v6, 52429, v5
    v_lshrrev_b32 v6, 21, v6
    v_and_b32 v6, 6, v6
    v_xor_b32 v5, v5, v6
    v_lshlrev_b32 v42, 4, v5
    v_xor_b32 v47, 0x80, v42
    v_add_u32 v5, 384, v20
    v_mul_u32_u24 v6, 52429, v5
    v_lshrrev_b32 v6, 21, v6
    v_and_b32 v6, 6, v6
    v_xor_b32 v5, v5, v6
    v_lshlrev_b32 v43, 4, v5
    v_xor_b32 v48, 0x80, v43
    v_add_u32 v5, 512, v20
    v_mul_u32_u24 v6, 52429, v5
    v_lshrrev_b32 v6, 21, v6
    v_and_b32 v6, 6, v6
    v_xor_b32 v5, v5, v6
    v_lshlrev_b32 v44, 4, v5
    v_xor_b32 v49, 0x80, v44
    v_lshrrev_b32 v5, 2, v0
    v_and_b32 v6, 3, v0
    v_lshlrev_b32 v6, 4, v6
    v_mul_u32_u24 v17, 3456, v5
    v_add_u32 v17, v17, v6
    s_waitcnt vmcnt(1)
    s_add_u32 m0, s11, 81920
    s_xor_b32 s14, s54, 65536
    buffer_load_dwordx4 v8, s[48:51], s14 offen nt lds
    s_waitcnt vmcnt(1)
    s_add_u32 m0, s11, 122880
    s_xor_b32 s14, s55, 98304
    buffer_load_dwordx4 v8, s[48:51], s14 offen nt lds
    s_waitcnt vmcnt(1)
    s_add_u32 m0, s11, 2048
    s_xor_b32 s14, s52, 8192
    buffer_load_dwordx4 v9, s[48:51], s14 offen nt lds
    s_waitcnt vmcnt(1)
    s_add_u32 m0, s11, 43008
    s_xor_b32 s14, s53, 40960
    buffer_load_dwordx4 v9, s[48:51], s14 offen nt lds
    s_add_u32 m0, s11, 83968
    s_xor_b32 s14, s54, 73728
    buffer_load_dwordx4 v9, s[48:51], s14 offen nt lds
    s_add_u32 m0, s11, 124928
    s_xor_b32 s14, s55, 106496
    buffer_load_dwordx4 v9, s[48:51], s14 offen nt lds
    s_add_u32 m0, s11, 4096
    s_xor_b32 s14, s52, 16384
    buffer_load_dwordx4 v8, s[48:51], s14 offen nt lds
    s_add_u32 m0, s11, 45056
    s_xor_b32 s14, s53, 49152
    buffer_load_dwordx4 v8, s[48:51], s14 offen nt lds
    s_add_u32 m0, s11, 86016
    s_xor_b32 s14, s54, 81920
    buffer_load_dwordx4 v8, s[48:51], s14 offen nt lds
    s_add_u32 m0, s11, 126976
    s_xor_b32 s14, s55, 114688
    buffer_load_dwordx4 v8, s[48:51], s14 offen nt lds
    s_waitcnt vmcnt(7)
    s_barrier
    s_add_u32 m0, s11, 6144
    s_xor_b32 s14, s52, 24576
    buffer_load_dwordx4 v9, s[48:51], s14 offen nt lds
    s_waitcnt vmcnt(7)
    s_add_u32 m0, s11, 47104
    s_xor_b32 s14, s53, 57344
    buffer_load_dwordx4 v9, s[48:51], s14 offen nt lds
    s_waitcnt vmcnt(7)
    s_add_u32 m0, s11, 88064
    s_xor_b32 s14, s54, 90112
    buffer_load_dwordx4 v9, s[48:51], s14 offen nt lds
    s_xor_b32 s14, s55, 122880
    buffer_load_dwordx4 v[24:27], v9, s[48:51], s14 offen nt
    s_add_u32 m0, s11, 32768
    s_xor_b32 s14, s53, 0
    buffer_load_dwordx4 v8, s[48:51], s14 offen nt lds
    s_add_u32 m0, s11, 8192
    s_xor_b32 s14, s52, 32768
    buffer_load_dwordx4 v8, s[48:51], s14 offen nt lds
    s_add_u32 m0, s11, 114688
    s_xor_b32 s14, s55, 65536
    buffer_load_dwordx4 v8, s[48:51], s14 offen nt lds
    s_add_u32 m0, s11, 90112
    s_xor_b32 s14, s54, 98304
    buffer_load_dwordx4 v8, s[48:51], s14 offen nt lds
    s_add_u32 m0, s11, 34816
    s_xor_b32 s14, s53, 8192
    buffer_load_dwordx4 v9, s[48:51], s14 offen nt lds
    s_add_u32 m0, s11, 10240
    s_xor_b32 s14, s52, 40960
    buffer_load_dwordx4 v9, s[48:51], s14 offen nt lds
    s_add_u32 m0, s11, 116736
    s_xor_b32 s14, s55, 73728
    buffer_load_dwordx4 v9, s[48:51], s14 offen nt lds
    s_waitcnt vmcnt(15)
    s_add_u32 m0, s11, 92160
    s_xor_b32 s14, s54, 106496
    buffer_load_dwordx4 v9, s[48:51], s14 offen nt lds
    s_waitcnt vmcnt(15)
    s_add_u32 m0, s11, 36864
    s_xor_b32 s14, s53, 16384
    buffer_load_dwordx4 v8, s[48:51], s14 offen nt lds
    s_waitcnt vmcnt(15)
    s_add_u32 m0, s11, 12288
    s_xor_b32 s14, s52, 49152
    buffer_load_dwordx4 v8, s[48:51], s14 offen nt lds
    s_waitcnt vmcnt(15)
    s_add_u32 m0, s11, 118784
    s_xor_b32 s14, s55, 81920
    buffer_load_dwordx4 v8, s[48:51], s14 offen nt lds
    s_waitcnt vmcnt(15)
    s_add_u32 m0, s11, 94208
    s_xor_b32 s14, s54, 114688
    buffer_load_dwordx4 v8, s[48:51], s14 offen nt lds
    s_waitcnt vmcnt(15)
    s_add_u32 m0, s11, 38912
    s_xor_b32 s14, s53, 24576
    buffer_load_dwordx4 v9, s[48:51], s14 offen nt lds
    s_waitcnt vmcnt(15)
    s_add_u32 m0, s11, 14336
    s_xor_b32 s14, s52, 57344
    buffer_load_dwordx4 v9, s[48:51], s14 offen nt lds
    s_waitcnt vmcnt(15)
    s_add_u32 m0, s11, 120832
    s_xor_b32 s14, s55, 90112
    buffer_load_dwordx4 v9, s[48:51], s14 offen nt lds
    s_waitcnt vmcnt(15)
    ds_write_b128 v19, v[24:27]
    s_mov_b64 exec, 1
    ds_add_u32 v3, v4 offset:196
    s_mov_b64 exec, -1
    s_add_u32 m0, s11, 96256
    s_xor_b32 s14, s54, 122880
    buffer_load_dwordx4 v9, s[48:51], s14 offen nt lds
    s_waitcnt vmcnt(15)
    s_add_u32 m0, s11, 65536
    s_xor_b32 s14, s54, 0
    buffer_load_dwordx4 v8, s[48:51], s14 offen nt lds
    s_waitcnt vmcnt(15)
    s_add_u32 m0, s11, 106496
    s_xor_b32 s14, s55, 32768
    buffer_load_dwordx4 v8, s[48:51], s14 offen nt lds
    s_waitcnt vmcnt(15)
    s_add_u32 m0, s11, 16384
    s_xor_b32 s14, s52, 65536
    buffer_load_dwordx4 v8, s[48:51], s14 offen nt lds
    s_waitcnt vmcnt(15)
    s_add_u32 m0, s11, 57344
    s_xor_b32 s14, s53, 98304
    buffer_load_dwordx4 v8, s[48:51], s14 offen nt lds
    s_waitcnt vmcnt(15)
    s_add_u32 m0, s11, 67584
    s_xor_b32 s14, s54, 8192
    buffer_load_dwordx4 v9, s[48:51], s14 offen nt lds
    s_waitcnt vmcnt(15)
    s_add_u32 m0, s11, 108544
    s_xor_b32 s14, s55, 40960
    buffer_load_dwordx4 v9, s[48:51], s14 offen nt lds
    s_waitcnt vmcnt(15)
    s_add_u32 m0, s11, 18432
    s_xor_b32 s14, s52, 73728
    buffer_load_dwordx4 v9, s[48:51], s14 offen nt lds
    s_waitcnt vmcnt(15)
    s_add_u32 m0, s11, 59392
    s_xor_b32 s14, s53, 106496
    buffer_load_dwordx4 v9, s[48:51], s14 offen nt lds
    s_waitcnt vmcnt(15)
    s_add_u32 m0, s11, 69632
    s_xor_b32 s14, s54, 16384
    buffer_load_dwordx4 v8, s[48:51], s14 offen nt lds
    s_waitcnt vmcnt(15)
    s_add_u32 m0, s11, 110592
    s_xor_b32 s14, s55, 49152
    buffer_load_dwordx4 v8, s[48:51], s14 offen nt lds
    s_waitcnt vmcnt(15)
    s_add_u32 m0, s11, 20480
    s_xor_b32 s14, s52, 81920
    buffer_load_dwordx4 v8, s[48:51], s14 offen nt lds
    s_waitcnt vmcnt(15)
    s_add_u32 m0, s11, 61440
    s_xor_b32 s14, s53, 114688
    buffer_load_dwordx4 v8, s[48:51], s14 offen nt lds
    s_waitcnt vmcnt(15)
    s_add_u32 m0, s11, 71680
    s_xor_b32 s14, s54, 24576
    buffer_load_dwordx4 v9, s[48:51], s14 offen nt lds
    s_waitcnt vmcnt(15)
    s_add_u32 m0, s11, 112640
    s_xor_b32 s14, s55, 57344
    buffer_load_dwordx4 v9, s[48:51], s14 offen nt lds
    s_waitcnt vmcnt(15)
    s_add_u32 m0, s11, 22528
    s_xor_b32 s14, s52, 90112
    buffer_load_dwordx4 v9, s[48:51], s14 offen nt lds
    s_waitcnt vmcnt(15)
    s_mov_b64 exec, 1
    ds_add_u32 v3, v4 offset:200
    s_mov_b64 exec, -1
    s_add_u32 m0, s11, 63488
    s_xor_b32 s14, s53, 122880
    buffer_load_dwordx4 v9, s[48:51], s14 offen nt lds
    s_waitcnt vmcnt(15)
    s_add_u32 m0, s11, 98304
    s_xor_b32 s14, s55, 0
    buffer_load_dwordx4 v8, s[48:51], s14 offen nt lds
    s_waitcnt vmcnt(15)
    s_add_u32 m0, s11, 73728
    s_xor_b32 s14, s54, 32768
    buffer_load_dwordx4 v8, s[48:51], s14 offen nt lds
    s_waitcnt vmcnt(15)
    s_add_u32 m0, s11, 49152
    s_xor_b32 s14, s53, 65536
    buffer_load_dwordx4 v8, s[48:51], s14 offen nt lds
    s_waitcnt vmcnt(15)
    s_add_u32 m0, s11, 24576
    s_xor_b32 s14, s52, 98304
    buffer_load_dwordx4 v8, s[48:51], s14 offen nt lds
    s_waitcnt vmcnt(15)
    s_add_u32 m0, s11, 100352
    s_xor_b32 s14, s55, 8192
    buffer_load_dwordx4 v9, s[48:51], s14 offen nt lds
    s_waitcnt vmcnt(15)
    s_add_u32 m0, s11, 75776
    s_xor_b32 s14, s54, 40960
    buffer_load_dwordx4 v9, s[48:51], s14 offen nt lds
    s_waitcnt vmcnt(15)
    s_add_u32 m0, s11, 51200
    s_xor_b32 s14, s53, 73728
    buffer_load_dwordx4 v9, s[48:51], s14 offen nt lds
    s_waitcnt vmcnt(15)
    s_add_u32 m0, s11, 26624
    s_xor_b32 s14, s52, 106496
    buffer_load_dwordx4 v9, s[48:51], s14 offen nt lds
    s_waitcnt vmcnt(15)
    s_add_u32 m0, s11, 102400
    s_xor_b32 s14, s55, 16384
    buffer_load_dwordx4 v8, s[48:51], s14 offen nt lds
    s_waitcnt vmcnt(15)
    s_add_u32 m0, s11, 77824
    s_xor_b32 s14, s54, 49152
    buffer_load_dwordx4 v8, s[48:51], s14 offen nt lds
    s_waitcnt vmcnt(15)
    s_add_u32 m0, s11, 53248
    s_xor_b32 s14, s53, 81920
    buffer_load_dwordx4 v8, s[48:51], s14 offen nt lds
    s_waitcnt vmcnt(15)
    s_add_u32 m0, s11, 28672
    s_xor_b32 s14, s52, 114688
    buffer_load_dwordx4 v8, s[48:51], s14 offen nt lds
    s_waitcnt vmcnt(15)
    s_add_u32 m0, s11, 104448
    s_xor_b32 s14, s55, 24576
    buffer_load_dwordx4 v9, s[48:51], s14 offen nt lds
    s_waitcnt vmcnt(15)
    s_add_u32 m0, s11, 79872
    s_xor_b32 s14, s54, 57344
    buffer_load_dwordx4 v9, s[48:51], s14 offen nt lds
    s_waitcnt vmcnt(15)
    s_add_u32 m0, s11, 55296
    s_xor_b32 s14, s53, 90112
    buffer_load_dwordx4 v9, s[48:51], s14 offen nt lds
    s_waitcnt vmcnt(15)
    s_mov_b64 exec, 1
    ds_add_u32 v3, v4 offset:204
    s_mov_b64 exec, -1
    s_add_u32 m0, s11, 30720
    s_xor_b32 s14, s52, 122880
    buffer_load_dwordx4 v9, s[48:51], s14 offen nt lds
    s_waitcnt vmcnt(15)
    s_waitcnt vmcnt(0)
    s_mov_b64 exec, 1
    ds_add_u32 v3, v4 offset:208
    s_mov_b64 exec, -1
LW_21:
    ds_read_b32 v5, v3 offset:20
    s_sub_u32 s70, s70, 1
    s_cbranch_scc1 L_EXIT
    s_waitcnt lgkmcnt(0)
    v_cmp_le_u32 vcc, 4, v5
    s_cbranch_vccnz LK_22
    s_sleep 1
    s_branch LW_21
LK_22:
    ds_write_b128 v19, v[24:27]
    s_mov_b64 exec, 1
    ds_add_u32 v3, v4 offset:12
    s_mov_b64 exec, -1
    s_cmp_lt_u32 s71, 27
    s_cbranch_scc1 L_ALD2
    s_branch L_EXIT
L_ALD2:
    s_mov_b32 s48, s34
    s_mov_b32 s49, s35
    s_mov_b32 s50, 2211840
    s_mov_b32 s51, 0x20000
    s_mul_i32 s12, s15, 40960
    s_add_u32 m0, s11, 147968
    s_add_u32 s14, s12, 20480
    buffer_load_dwordx4 v44, s[48:51], s14 offen nt lds
    s_add_u32 m0, s11, 150016
    s_add_u32 s14, s12, 30720
    buffer_load_dwordx4 v45, s[48:51], s14 offen nt lds
    s_add_u32 m0, s11, 152064
    s_add_u32 s14, s12, 30720
    buffer_load_dwordx4 v46, s[48:51], s14 offen nt lds
    s_add_u32 m0, s11, 154112
    s_add_u32 s14, s12, 30720
    buffer_load_dwordx4 v47, s[48:51], s14 offen nt lds
    s_add_u32 m0, s11, 156160
    s_add_u32 s14, s12, 30720
    buffer_load_dwordx4 v48, s[48:51], s14 offen nt lds
    s_add_u32 m0, s11, 158208
    s_add_u32 s14, s12, 30720
    buffer_load_dwordx4 v49, s[48:51], s14 offen nt lds
LW_23:
    ds_read_b32 v5, v3 offset:44
    s_sub_u32 s70, s70, 1
    s_cbranch_scc1 L_EXIT
    s_waitcnt lgkmcnt(0)
    v_cmp_le_u32 vcc, 4, v5
    s_cbranch_vccnz LK_24
    s_sleep 2
    s_branch LW_23
LK_24:
    s_mov_b32 s48, s34
    s_mov_b32 s49, s35
    s_mov_b32 s50, 2211840
    s_mov_b32 s51, 0x20000
    s_mul_i32 s12, s15, 40960
    s_add_u32 m0, s11, 119296
    s_add_u32 s14, s12, 0
    buffer_load_dwordx4 v40, s[48:51], s14 offen nt lds
    s_add_u32 m0, s11, 121344
    s_add_u32 s14, s12, 0
    buffer_load_dwordx4 v41, s[48:51], s14 offen nt lds
    s_add_u32 m0, s11, 123392
    s_add_u32 s14, s12, 0
    buffer_load_dwordx4 v42, s[48:51], s14 offen nt lds
    s_add_u32 m0, s11, 125440
    s_add_u32 s14, s12, 0
    buffer_load_dwordx4 v43, s[48:51], s14 offen nt lds
    s_add_u32 m0, s11, 127488
    s_add_u32 s14, s12, 0
    buffer_load_dwordx4 v44, s[48:51], s14 offen nt lds
    s_add_u32 m0, s11, 129536
    s_add_u32 s14, s12, 10240
    buffer_load_dwordx4 v45, s[48:51], s14 offen nt lds
    s_add_u32 m0, s11, 131584
    s_add_u32 s14, s12, 10240
    buffer_load_dwordx4 v46, s[48:51], s14 offen nt lds
    s_add_u32 m0, s11, 133632
    s_add_u32 s14, s12, 10240
    buffer_load_dwordx4 v47, s[48:51], s14 offen nt lds
    s_add_u32 m0, s11, 135680
    s_add_u32 s14, s12, 10240
    buffer_load_dwordx4 v48, s[48:51], s14 offen nt lds
    s_add_u32 m0, s11, 137728
    s_add_u32 s14, s12, 10240
    buffer_load_dwordx4 v49, s[48:51], s14 offen nt lds
    s_waitcnt vmcnt(15)
    s_add_u32 m0, s11, 139776
    s_add_u32 s14, s12, 20480
    buffer_load_dwordx4 v40, s[48:51], s14 offen nt lds
    s_waitcnt vmcnt(15)
    s_add_u32 m0, s11, 141824
    s_add_u32 s14, s12, 20480
    buffer_load_dwordx4 v41, s[48:51], s14 offen nt lds
    s_waitcnt vmcnt(15)
    s_add_u32 m0, s11, 143872
    s_add_u32 s14, s12, 20480
    buffer_load_dwordx4 v42, s[48:51], s14 offen nt lds
    s_waitcnt vmcnt(15)
    s_add_u32 m0, s11, 145920
    s_add_u32 s14, s12, 20480
    buffer_load_dwordx4 v43, s[48:51], s14 offen nt lds
    s_waitcnt vmcnt(15)
    s_mov_b32 s48, s30
    s_mov_b32 s49, s31
    s_mov_b32 s50, 2211840
    s_mov_b32 s51, 0x20000
    s_lshl_b32 s12, s15, 6
    s_mul_i32 s9, s10, 16*3456
    s_add_u32 s12, s12, s9
    s_and_b32 s8, s15, 1
    s_mul_i32 s9, s8, 320*3456
    s_add_u32 s13, s12, s9
    s_sub_u32 s12, s12, s9
    s_mul_i32 s9, s8, 20480
    s_add_u32 s11, s11, s9
    s_add_u32 m0, s11, 0
    s_add_u32 s14, s13, 0
    buffer_load_dwordx4 v17, s[48:51], s14 offen  lds
    s_waitcnt vmcnt(11)
    s_add_u32 m0, s11, 2048
    s_add_u32 s14, s13, 110592
    buffer_load_dwordx4 v17, s[48:51], s14 offen  lds
    s_waitcnt vmcnt(11)
    s_add_u32 m0, s11, 4096
    s_add_u32 s14, s13, 221184
    buffer_load_dwordx4 v17, s[48:51], s14 offen  lds
    s_waitcnt vmcnt(11)
    s_add_u32 m0, s11, 6144
    s_add_u32 s14, s13, 331776
    buffer_load_dwordx4 v17, s[48:51], s14 offen  lds
    s_waitcnt vmcnt(11)
    s_add_u32 m0, s11, 8192
    s_add_u32 s14, s13, 442368
    buffer_load_dwordx4 v17, s[48:51], s14 offen  lds
    s_waitcnt vmcnt(11)
    s_add_u32 m0, s11, 10240
    s_add_u32 s14, s13, 552960
    buffer_load_dwordx4 v17, s[48:51], s14 offen  lds
    s_waitcnt vmcnt(11)
    s_add_u32 m0, s11, 12288
    s_add_u32 s14, s13, 663552
    buffer_load_dwordx4 v17, s[48:51], s14 offen  lds
    s_waitcnt vmcnt(11)
    s_add_u32 m0, s11, 14336
    s_add_u32 s14, s13, 774144
    buffer_load_dwordx4 v17, s[48:51], s14 offen  lds
    s_waitcnt vmcnt(11)
    s_add_u32 m0, s11, 16384
    s_add_u32 s14, s13, 884736
    buffer_load_dwordx4 v17, s[48:51], s14 offen  lds
    s_waitcnt vmcnt(11)
    s_add_u32 m0, s11, 18432
    s_add_u32 s14, s13, 995328
    buffer_load_dwordx4 v17, s[48:51], s14 offen  lds
    s_waitcnt vmcnt(11)
    s_sub_u32 s11, s11, s9
    s_sub_u32 s11, s11, s9
    s_add_u32 m0, s11, 20480
    s_add_u32 s14, s12, 1105920
    buffer_load_dwordx4 v17, s[48:51], s14 offen  lds
    s_waitcnt vmcnt(11)
    s_mov_b64 exec, 1
    ds_add_u32 v3, v4 offset:216
    s_mov_b64 exec, -1
    s_add_u32 m0, s11, 22528
    s_add_u32 s14, s12, 1216512
    buffer_load_dwordx4 v17, s[48:51], s14 offen  lds
    s_waitcnt vmcnt(11)
    s_add_u32 m0, s11, 24576
    s_add_u32 s14, s12, 1327104
    buffer_load_dwordx4 v17, s[48:51], s14 offen  lds
    s_waitcnt vmcnt(11)
    s_add_u32 m0, s11, 26624
    s_add_u32 s14, s12, 1437696
    buffer_load_dwordx4 v17, s[48:51], s14 offen  lds
    s_waitcnt vmcnt(11)
    s_add_u32 m0, s11, 28672
    s_add_u32 s14, s12, 1548288
    buffer_load_dwordx4 v17, s[48:51], s14 offen  lds
    s_waitcnt vmcnt(11)
    s_add_u32 m0, s11, 30720
    s_add_u32 s14, s12, 1658880
    buffer_load_dwordx4 v17, s[48:51], s14 offen  lds
    s_waitcnt vmcnt(11)
    s_add_u32 m0, s11, 32768
    s_add_u32 s14, s12, 1769472
    buffer_load_dwordx4 v17, s[48:51], s14 offen  lds
    s_waitcnt vmcnt(11)
    s_add_u32 m0, s11, 34816
    s_add_u32 s14, s12, 1880064
    buffer_load_dwordx4 v17, s[48:51], s14 offen  lds
    s_waitcnt vmcnt(11)
    s_add_u32 m0, s11, 36864
    s_add_u32 s14, s12, 1990656
    buffer_load_dwordx4 v17, s[48:51], s14 offen  lds
    s_waitcnt vmcnt(11)
    s_add_u32 m0, s11, 38912
    s_add_u32 s14, s12, 2101248
    buffer_load_dwordx4 v17, s[48:51], s14 offen  lds
    s_waitcnt vmcnt(11)
    s_add_u32 s11, s11, s9
    s_waitcnt vmcnt(0)
    s_mov_b64 exec, 1
    ds_add_u32 v3, v4 offset:212
    s_mov_b64 exec, -1
    s_branch L_EXIT
    .p2align 10
L_A1:
    v_subrev_u32 v6, 16, v0
    v_cmp_gt_u32 vcc, 32, v6
    v_mov_b32 v5, 0xff800000
    s_nop 0
    v_cndmask_b32 v5, 0, v5, vcc
    v_lshl_add_u32 v6, v0, 2, v3
    ds_write_b32 v6, v5
    s_waitcnt lgkmcnt(0)
    s_load_dword s40, s[42:43], 131072
    s_barrier
    s_and_b32 s8, s2, 63
    s_mul_i32 s8, s8, 67712
    s_add_u32 s12, s8, 8454144
    v_lshl_add_u32 v7, v0, 2, v3
    s_waitcnt lgkmcnt(0)
    s_add_u32 s8, s40, 0x11111111
    s_mov_b32 s9, s8
LW_25:
    ds_read_b32 v5, v3 offset:196
    s_sub_u32 s70, s70, 1
    s_cbranch_scc1 L_EXIT
    s_waitcnt lgkmcnt(0)
    v_cmp_le_u32 vcc, 2, v5
    s_cbranch_vccnz LK_26
    s_sleep 4
    s_branch LW_25
LK_26:
    s_setprio 3
L_GO0:
    s_load_dwordx8 s[20:27], s[42:43], s12 glc
    s_sub_u32 s70, s70, 1
    s_cbranch_scc1 L_EXIT
    s_waitcnt lgkmcnt(0)
    s_mov_b32 s10, 0
    s_cmp_eq_u64 s[20:21], s[8:9]
    s_cselect_b32 s11, 1, 0
    s_or_b32 s10, s10, s11
    s_cmp_eq_u64 s[22:23], s[8:9]
    s_cselect_b32 s11, 2, 0
    s_or_b32 s10, s10, s11
    s_cmp_eq_u64 s[24:25], s[8:9]
    s_cselect_b32 s11, 4, 0
    s_or_b32 s10, s10, s11
    s_cmp_eq_u64 s[26:27], s[8:9]
    s_cselect_b32 s11, 8, 0
    s_or_b32 s10, s10, s11
    s_cbranch_scc0 L_GO0
    s_mov_b32 exec_lo, s10
    s_mov_b32 exec_hi, 0
    ds_write_b32 v7, v4 offset:224
    s_cmp_eq_u32 s10, 15
    s_cbranch_scc0 L_GO0
    s_mov_b64 exec, -1
    s_load_dwordx2 s[52:53], s[0:1], 96
    v_mov_b32 v15, s8
    s_lshr_b32 s10, s7, 5
    s_lshl_b32 s9, s10, 6
    v_mov_b32 v12, s9
    s_lshl_b32 s10, s10, 2
    s_add_u32 s10, s10, 163840
    v_lshl_add_u32 v13, v0, 7, s10
LW_27:
    ds_read_b32 v5, v3 offset:208
    s_sub_u32 s70, s70, 1
    s_cbranch_scc1 L_EXIT
    s_waitcnt lgkmcnt(0)
    v_cmp_le_u32 vcc, 2, v5
    s_cbranch_vccnz LK_28
    s_sleep 1
    s_branch LW_27
LK_28:
LW_29:
    ds_read_b32 v5, v3 offset:4
    s_sub_u32 s70, s70, 1
    s_cbranch_scc1 L_EXIT
    s_waitcnt lgkmcnt(0)
    v_cmp_le_u32 vcc, 4, v5
    s_cbranch_vccnz LK_30
    s_sleep 1
    s_branch LW_29
LK_30:
    s_mov_b64 exec, 1
    global_atomic_add v6, v12, v4, s[52:53] sc0 sc1
    ds_add_u32 v3, v4 offset:60
    s_waitcnt vmcnt(0)
    v_readfirstlane_b32 s10, v6
    s_and_b32 s10, s10, 31
    s_cmp_eq_u32 s10, 31
    s_cbranch_scc0 L_A51
    s_mov_b64 exec, -1
LW_31:
    ds_read_b32 v5, v3 offset:16
    s_sub_u32 s70, s70, 1
    s_cbranch_scc1 L_EXIT
    s_waitcnt lgkmcnt(0)
    v_cmp_le_u32 vcc, 4, v5
    s_cbranch_vccz LW_31
    s_mov_b32 exec_lo, 0xffffffff
    s_mov_b32 exec_hi, 0xffffffff
    global_store_dword v13, v15, s[42:43] sc1
L_A51:
    s_mov_b64 exec, -1
    s_cmp_lt_u32 s71, 27
    s_cbranch_scc0 L_EXIT
LW_32:
    ds_read_b32 v5, v3 offset:44
    s_sub_u32 s70, s70, 1
    s_cbranch_scc1 L_EXIT
    s_waitcnt lgkmcnt(0)
    v_cmp_le_u32 vcc, 4, v5
    s_cbranch_vccnz LK_33
    s_sleep 8
    s_branch LW_32
LK_33:
    s_sleep 32
    s_lshl_b32 s8, s15, 7
    s_add_u32 s12, s8, 180224
    v_readfirstlane_b32 s8, v15
    v_readfirstlane_b32 s9, v15
    s_branch L_F21
L_F20:
L_F21:
    s_load_dwordx8 s[20:27], s[42:43], s12 glc
    s_sub_u32 s70, s70, 1
    s_cbranch_scc1 L_EXIT
    s_waitcnt lgkmcnt(0)
    s_xor_b64 s[20:21], s[20:21], s[8:9]
    s_xor_b64 s[22:23], s[22:23], s[8:9]
    s_xor_b64 s[24:25], s[24:25], s[8:9]
    s_xor_b64 s[26:27], s[26:27], s[8:9]
    s_or_b64 s[20:21], s[20:21], s[22:23]
    s_or_b64 s[24:25], s[24:25], s[26:27]
    s_or_b64 s[20:21], s[20:21], s[24:25]
    s_cbranch_scc1 L_F20
    s_mov_b64 exec, 1
    ds_add_u32 v3, v4 offset:40
    s_mov_b64 exec, -1
    s_branch L_EXIT
    .p2align 10
L_A2:
    s_barrier
    s_waitcnt lgkmcnt(0)
    s_load_dword s40, s[42:43], 131072
    v_and_b32 v12, 31, v0
    v_lshrrev_b32 v13, 5, v0
    v_mul_u32_u24 v14, 272, v12
    v_add_u32 v14, 131072, v14
    v_lshl_add_u32 v15, v13, 4, v14
    v_lshl_add_u32 v16, v12, 2, v3
    s_waitcnt lgkmcnt(0)
    s_add_u32 s40, s40, 0x11111111
    s_mov_b32 s41, 0xfffefffe
    s_mov_b32 s29, 0x07060302
    s_mov_b32 s28, 0x00010001
    s_mov_b32 s44, s42
    s_mov_b32 s45, s43
    s_mov_b32 s46, 268435456
    s_mov_b32 s47, 0x20000
    s_not_b32 s8, s40
    v_and_b32 v5, 3, v0
    v_lshlrev_b32 v5, 2, v5
    v_lshrrev_b32 v5, v5, s8
    v_lshrrev_b32 v6, 0, v5
    v_and_b32 v8, s28, v6
    v_lshrrev_b32 v6, 1, v5
    v_and_b32 v9, s28, v6
    v_lshrrev_b32 v6, 2, v5
    v_and_b32 v10, s28, v6
    v_lshrrev_b32 v6, 3, v5
    v_and_b32 v11, s28, v6
    s_cmp_eq_u32 s3, 4
    s_cbranch_scc1 L_A4
    s_lshl_b32 s8, s3, 6
    v_add_u32 v14, s8, v15
    s_mul_i32 s8, s3, 270336
    s_add_u32 s8, s8, 7340032
    v_lshl_add_u32 v17, v0, 4, s8
    v_add_u32 v18, 135168, v17
    s_lshl_b32 s8, s3, 3
    v_lshrrev_b32 v5, 2, v1
    v_lshl_add_u32 v5, v13, 5, v5
    v_add_u32 v5, s8, v5
    v_and_b32 v6, 3, v1
    v_lshlrev_b32 v7, 1, v6
    v_xor_b32 v5, v5, v7
    v_and_b32 v7, 1, v2
    v_lshl_add_u32 v6, v7, 2, v6
    v_lshlrev_b32 v6, 10, v6
    v_lshl_add_u32 v38, v5, 4, v6
    v_add_u32 v38, 130048, v38
    v_xor_b32 v39, 64, v38
    s_mov_b32 s13, s3
    s_lshl_b32 s9, s13, 15
    s_lshl_b32 s10, s3, 13
    s_add_u32 s9, s9, s10
    v_and_b32 v5, 3, v1
    v_lshlrev_b32 v5, 2, v5
    v_lshrrev_b32 v6, 2, v1
    v_or_b32 v5, v5, v6
    v_lshlrev_b32 v6, 3, v13
    v_xor_b32 v5, v5, v6
    v_xor_b32 v6, 0, v5
    v_lshlrev_b32 v6, 4, v6
    v_lshl_add_u32 v6, v12, 8, v6
    v_add_u32 v20, s9, v6
    v_xor_b32 v6, 1, v5
    v_lshlrev_b32 v6, 4, v6
    v_lshl_add_u32 v6, v12, 8, v6
    v_add_u32 v21, s9, v6
    v_xor_b32 v6, 2, v5
    v_lshlrev_b32 v6, 4, v6
    v_lshl_add_u32 v6, v12, 8, v6
    v_add_u32 v22, s9, v6
    v_xor_b32 v6, 3, v5
    v_lshlrev_b32 v6, 4, v6
    v_lshl_add_u32 v6, v12, 8, v6
    v_add_u32 v23, s9, v6
    v_xor_b32 v6, 4, v5
    v_lshlrev_b32 v6, 4, v6
    v_lshl_add_u32 v6, v12, 8, v6
    v_add_u32 v24, s9, v6
    v_xor_b32 v6, 5, v5
    v_lshlrev_b32 v6, 4, v6
    v_lshl_add_u32 v6, v12, 8, v6
    v_add_u32 v25, s9, v6
    v_xor_b32 v6, 6, v5
    v_lshlrev_b32 v6, 4, v6
    v_lshl_add_u32 v6, v12, 8, v6
    v_add_u32 v26, s9, v6
    v_xor_b32 v6, 7, v5
    v_lshlrev_b32 v6, 4, v6
    v_lshl_add_u32 v6, v12, 8, v6
    v_add_u32 v27, s9, v6
    s_and_b32 s14, s6, 3
    s_xor_b32 s13, s13, s14
    s_xor_b32 s8, s13, 0
    s_lshl_b32 s8, s8, 13
    s_add_u32 s8, s8, 130048
    v_xor_b32 v6, 0, v0
    v_lshl_add_u32 v248, v6, 4, s8
    v_xor_b32 v6, 2, v0
    v_lshl_add_u32 v249, v6, 4, s8
    v_xor_b32 v6, 4, v0
    v_lshl_add_u32 v250, v6, 4, s8
    v_xor_b32 v6, 6, v0
    v_lshl_add_u32 v251, v6, 4, s8
    s_xor_b32 s8, s13, 1
    s_lshl_b32 s8, s8, 13
    s_add_u32 s8, s8, 130048
    v_xor_b32 v6, 0, v0
    v_lshl_add_u32 v252, v6, 4, s8
    v_xor_b32 v6, 2, v0
    v_lshl_add_u32 v253, v6, 4, s8
    v_xor_b32 v6, 4, v0
    v_lshl_add_u32 v254, v6, 4, s8
    v_xor_b32 v6, 6, v0
    v_lshl_add_u32 v255, v6, 4, s8
    s_and_b32 s8, s13, 2
    s_mov_b32 s68, 0x4000
    s_cselect_b32 s68, 0xffffc000, s68
    v_lshrrev_b32 v5, 2, v1
    v_and_b32 v6, 3, v1
    v_and_b32 v7, 1, v2
    v_lshlrev_b32 v7, 1, v7
    v_lshrrev_b32 v19, 1, v6
    v_add_u32 v7, v7, v19
    v_lshl_add_u32 v19, v5, 2, v13
    v_xor_b32 v7, v7, v19
    v_lshl_add_u32 v19, v13, 2, v5
    v_lshlrev_b32 v19, 8, v19
    v_and_b32 v6, 1, v6
    v_lshl_add_u32 v19, v6, 3, v19
    s_xor_b32 s8, s3, 3
    s_lshl_b32 s8, s8, 15
    s_lshl_b32 s9, s3, 13
    s_add_u32 s8, s8, s9
    v_add_u32 v19, s8, v19
    v_xor_b32 v6, 0, v7
    v_lshl_add_u32 v28, v6, 4, v19
    v_xor_b32 v6, 2, v7
    v_lshl_add_u32 v29, v6, 4, v19
    v_xor_b32 v6, 4, v7
    v_lshl_add_u32 v30, v6, 4, v19
    v_xor_b32 v6, 6, v7
    v_lshl_add_u32 v31, v6, 4, v19
    v_xor_b32 v6, 8, v7
    v_lshl_add_u32 v32, v6, 4, v19
    v_xor_b32 v6, 10, v7
    v_lshl_add_u32 v33, v6, 4, v19
    v_xor_b32 v6, 12, v7
    v_lshl_add_u32 v34, v6, 4, v19
    v_xor_b32 v6, 14, v7
    v_lshl_add_u32 v35, v6, 4, v19
    s_lshl_b32 s8, s3, 3
    s_add_u32 s8, s8, -1280
    v_lshl_add_u32 v19, v12, 5, v3
    v_lshl_add_u32 v19, v13, 2, v19
    v_add_u32 v19, s8, v19
    s_xor_b32 s8, s3, s14
    s_xor_b32 s8, s8, 3
    s_lshl_b32 s8, s8, 15
    s_lshl_b32 s9, s7, 8
    s_add_u32 s8, s8, s9
    s_add_u32 s12, s8, 1048576
    v_lshlrev_b32 v36, 19, v13
    v_lshl_add_u32 v36, v12, 2, v36
    v_lshrrev_b32 v37, v1, s40
    v_and_b32 v37, s28, v37
LW_34:
    ds_read_b32 v5, v3 offset:196
    s_sub_u32 s70, s70, 1
    s_cbranch_scc1 L_EXIT
    s_waitcnt lgkmcnt(0)
    v_cmp_le_u32 vcc, 2, v5
    s_cbranch_vccnz LK_35
    s_sleep 2
    s_branch LW_34
LK_35:
    ds_read_b128 v[40:43], v20
    ds_read_b128 v[44:47], v21
    ds_read_b128 v[48:51], v22
    ds_read_b128 v[52:55], v23
    ds_read_b128 v[56:59], v24
    ds_read_b128 v[60:63], v25
    ds_read_b128 v[64:67], v26
    ds_read_b128 v[68:71], v27
    v_xor_b32 v20, 0x8000, v20
    v_xor_b32 v21, 0x8000, v21
    v_xor_b32 v22, 0x8000, v22
    v_xor_b32 v23, 0x8000, v23
    v_xor_b32 v24, 0x8000, v24
    v_xor_b32 v25, 0x8000, v25
    v_xor_b32 v26, 0x8000, v26
    v_xor_b32 v27, 0x8000, v27
    s_mov_b64 exec, 1
    ds_add_u32 v3, v4 offset:52
    s_mov_b64 exec, -1
LW_36:
    ds_read_b32 v5, v3 offset:52
    s_sub_u32 s70, s70, 1
    s_cbranch_scc1 L_EXIT
    s_waitcnt lgkmcnt(0)
    v_cmp_le_u32 vcc, 4, v5
    s_cbranch_vccnz LK_37
    s_sleep 1
    s_branch LW_36
LK_37:
    s_setprio 3
    s_lshl_b32 s8, s3, 2
    v_add_u32 v7, s8, v3
LW_38:
    ds_read_b32 v5, v7 offset:224
    s_sub_u32 s70, s70, 1
    s_cbranch_scc1 L_EXIT
    s_waitcnt lgkmcnt(0)
    v_cmp_le_u32 vcc, 1, v5
    s_cbranch_vccnz LK_39
    s_sleep 1
    s_branch LW_38
LK_39:
    global_load_dwordx4 v[136:139], v17, s[42:43] offset:0 sc1
    global_load_dwordx4 v[140:143], v17, s[42:43] offset:1024 sc1
    global_load_dwordx4 v[144:147], v17, s[42:43] offset:2048 sc1
    global_load_dwordx4 v[148:151], v17, s[42:43] offset:3072 sc1
    global_load_dwordx4 v[152:155], v18, s[42:43] offset:0 sc1
    global_load_dwordx4 v[156:159], v18, s[42:43] offset:1024 sc1
    global_load_dwordx4 v[160:163], v18, s[42:43] offset:2048 sc1
    global_load_dwordx4 v[164:167], v18, s[42:43] offset:3072 sc1
LW_40:
    ds_read_b32 v5, v3 offset:200
    s_sub_u32 s70, s70, 1
    s_cbranch_scc1 L_EXIT
    s_waitcnt lgkmcnt(0)
    v_cmp_le_u32 vcc, 2, v5
    s_cbranch_vccnz LK_41
    s_sleep 1
    s_branch LW_40
LK_41:
    ds_read_b128 v[72:75], v20
    ds_read_b128 v[76:79], v21
    ds_read_b128 v[80:83], v22
    ds_read_b128 v[84:87], v23
    ds_read_b128 v[88:91], v24
    ds_read_b128 v[92:95], v25
    ds_read_b128 v[96:99], v26
    ds_read_b128 v[100:103], v27
    v_xor_b32 v20, 0x18000, v20
    v_xor_b32 v21, 0x18000, v21
    v_xor_b32 v22, 0x18000, v22
    v_xor_b32 v23, 0x18000, v23
    v_xor_b32 v24, 0x18000, v24
    v_xor_b32 v25, 0x18000, v25
    v_xor_b32 v26, 0x18000, v26
    v_xor_b32 v27, 0x18000, v27
    s_mov_b32 s10, 0
    ds_read_b32 v5, v3 offset:204
    s_waitcnt lgkmcnt(0)
    v_cmp_le_u32 vcc, 2, v5
    s_cbranch_vccz L_C2A
    ds_read_b128 v[104:107], v20
    ds_read_b128 v[108:111], v21
    ds_read_b128 v[112:115], v22
    ds_read_b128 v[116:119], v23
    ds_read_b128 v[120:123], v24
    ds_read_b128 v[124:127], v25
    ds_read_b128 v[128:131], v26
    ds_read_b128 v[132:135], v27
    v_xor_b32 v20, 0x8000, v20
    v_xor_b32 v21, 0x8000, v21
    v_xor_b32 v22, 0x8000, v22
    v_xor_b32 v23, 0x8000, v23
    v_xor_b32 v24, 0x8000, v24
    v_xor_b32 v25, 0x8000, v25
    v_xor_b32 v26, 0x8000, v26
    v_xor_b32 v27, 0x8000, v27
    s_mov_b32 s10, 1
L_C2A:
    s_waitcnt vmcnt(7)
    v_xor_b32 v136, v136, v8
    v_xor_b32 v137, v137, v9
    v_xor_b32 v138, v138, v10
    v_xor_b32 v139, v139, v11
    ds_write_b128 v38, v[136:139] offset:0
    v_bitop3_b32 v168, v136, v137, v138 bitop3:0x80
    v_bitop3_b32 v168, v168, v139, s28 bitop3:0x80
    s_waitcnt vmcnt(6)
    v_xor_b32 v140, v140, v8
    v_xor_b32 v141, v141, v9
    v_xor_b32 v142, v142, v10
    v_xor_b32 v143, v143, v11
    ds_write_b128 v38, v[140:143] offset:8192
    v_bitop3_b32 v169, v140, v141, v142 bitop3:0x80
    v_bitop3_b32 v169, v169, v143, s28 bitop3:0x80
    s_waitcnt vmcnt(5)
    v_xor_b32 v144, v144, v8
    v_xor_b32 v145, v145, v9
    v_xor_b32 v146, v146, v10
    v_xor_b32 v147, v147, v11
    ds_write_b128 v38, v[144:147] offset:16384
    v_bitop3_b32 v170, v144, v145, v146 bitop3:0x80
    v_bitop3_b32 v170, v170, v147, s28 bitop3:0x80
    s_waitcnt vmcnt(4)
    v_xor_b32 v148, v148, v8
    v_xor_b32 v149, v149, v9
    v_xor_b32 v150, v150, v10
    v_xor_b32 v151, v151, v11
    ds_write_b128 v38, v[148:151] offset:24576
    v_bitop3_b32 v171, v148, v149, v150 bitop3:0x80
    v_bitop3_b32 v171, v171, v151, s28 bitop3:0x80
    s_waitcnt vmcnt(3)
    v_xor_b32 v152, v152, v8
    v_xor_b32 v153, v153, v9
    v_xor_b32 v154, v154, v10
    v_xor_b32 v155, v155, v11
    ds_write_b128 v39, v[152:155] offset:0
    v_bitop3_b32 v172, v152, v153, v154 bitop3:0x80
    v_bitop3_b32 v172, v172, v155, s28 bitop3:0x80
    s_waitcnt vmcnt(2)
    v_xor_b32 v156, v156, v8
    v_xor_b32 v157, v157, v9
    v_xor_b32 v158, v158, v10
    v_xor_b32 v159, v159, v11
    ds_write_b128 v39, v[156:159] offset:8192
    v_bitop3_b32 v173, v156, v157, v158 bitop3:0x80
    v_bitop3_b32 v173, v173, v159, s28 bitop3:0x80
    s_waitcnt vmcnt(1)
    v_xor_b32 v160, v160, v8
    v_xor_b32 v161, v161, v9
    v_xor_b32 v162, v162, v10
    v_xor_b32 v163, v163, v11
    ds_write_b128 v39, v[160:163] offset:16384
    v_bitop3_b32 v174, v160, v161, v162 bitop3:0x80
    v_bitop3_b32 v174, v174, v163, s28 bitop3:0x80
    s_waitcnt vmcnt(0)
    v_xor_b32 v164, v164, v8
    v_xor_b32 v165, v165, v9
    v_xor_b32 v166, v166, v10
    v_xor_b32 v167, v167, v11
    ds_write_b128 v39, v[164:167] offset:24576
    v_bitop3_b32 v175, v164, v165, v166 bitop3:0x80
    v_bitop3_b32 v175, v175, v167, s28 bitop3:0x80
    v_bitop3_b32 v5, v168, v169, v170 bitop3:0x80
    v_bitop3_b32 v5, v5, v171, v172 bitop3:0x80
    v_bitop3_b32 v5, v5, v173, v174 bitop3:0x80
    v_bitop3_b32 v5, v5, v175, s28 bitop3:0x80
    v_cmp_ne_u32 vcc, s28, v5
    s_cbranch_vccnz L_GR
L_GD:
    s_mov_b64 exec, 1
    ds_add_u32 v3, v4 offset:4
    s_mov_b64 exec, -1
    s_cmp_eq_u32 s10, 0
    s_cbranch_scc1 L_C2B
L_C2C:
LW_42:
    ds_read_b32 v5, v3 offset:4
    ds_read_b128 v[136:139], v248 offset:0
    ds_read_b128 v[140:143], v249 offset:1024
    s_sub_u32 s70, s70, 1
    s_cbranch_scc1 L_EXIT
    s_waitcnt lgkmcnt(0)
    v_cmp_le_u32 vcc, 4, v5
    s_cbranch_vccz LW_42
    ds_read_b128 v[144:147], v250 offset:2048
    ds_read_b128 v[148:151], v251 offset:3072
    ds_read_b128 v[152:155], v248 offset:4096
    ds_read_b128 v[156:159], v249 offset:5120
    v_mfma_f32_32x32x16_bf16 v[232:247], v[40:43], v[136:139], 0
    ds_read_b128 v[160:163], v250 offset:6144
    ds_read_b128 v[164:167], v251 offset:7168
    v_mfma_f32_32x32x16_bf16 v[232:247], v[44:47], v[140:143], v[232:247]
    ds_read_b128 v[168:171], v252 offset:0
    ds_read_b128 v[172:175], v253 offset:1024
    s_waitcnt lgkmcnt(6)
    v_mfma_f32_32x32x16_bf16 v[232:247], v[48:51], v[144:147], v[232:247]
    ds_read_b128 v[176:179], v254 offset:2048
    ds_read_b128 v[180:183], v255 offset:3072
    v_mfma_f32_32x32x16_bf16 v[232:247], v[52:55], v[148:151], v[232:247]
    ds_read_b128 v[184:187], v252 offset:4096
    ds_read_b128 v[188:191], v253 offset:5120
    s_waitcnt lgkmcnt(8)
    v_mfma_f32_32x32x16_bf16 v[232:247], v[56:59], v[152:155], v[232:247]
    ds_read_b128 v[192:195], v254 offset:6144
    ds_read_b128 v[196:199], v255 offset:7168
    v_mfma_f32_32x32x16_bf16 v[232:247], v[60:63], v[156:159], v[232:247]
    v_add_u32 v248, s68, v248
    ds_read_b128 v[200:203], v248 offset:0
    v_add_u32 v249, s68, v249
    ds_read_b128 v[204:207], v249 offset:1024
    s_waitcnt lgkmcnt(10)
    v_mfma_f32_32x32x16_bf16 v[232:247], v[64:67], v[160:163], v[232:247]
    v_add_u32 v250, s68, v250
    ds_read_b128 v[208:211], v250 offset:2048
    v_add_u32 v251, s68, v251
    ds_read_b128 v[212:215], v251 offset:3072
    v_mfma_f32_32x32x16_bf16 v[232:247], v[68:71], v[164:167], v[232:247]
    ds_read_b128 v[216:219], v248 offset:4096
    ds_read_b128 v[220:223], v249 offset:5120
    s_waitcnt lgkmcnt(12)
    v_mfma_f32_32x32x16_bf16 v[232:247], v[72:75], v[168:171], v[232:247]
    ds_read_b128 v[224:227], v250 offset:6144
    ds_read_b128 v[228:231], v251 offset:7168
    v_mfma_f32_32x32x16_bf16 v[232:247], v[76:79], v[172:175], v[232:247]
    v_add_u32 v252, s68, v252
    ds_read_b128 v[40:43], v252 offset:0
    v_add_u32 v253, s68, v253
    ds_read_b128 v[44:47], v253 offset:1024
    s_waitcnt lgkmcnt(14)
    v_mfma_f32_32x32x16_bf16 v[232:247], v[80:83], v[176:179], v[232:247]
    v_add_u32 v254, s68, v254
    ds_read_b128 v[48:51], v254 offset:2048
    v_add_u32 v255, s68, v255
    ds_read_b128 v[52:55], v255 offset:3072
    v_mfma_f32_32x32x16_bf16 v[232:247], v[84:87], v[180:183], v[232:247]
    ds_read_b128 v[56:59], v252 offset:4096
    ds_read_b128 v[60:63], v253 offset:5120
    v_mfma_f32_32x32x16_bf16 v[232:247], v[88:91], v[184:187], v[232:247]
    ds_read_b128 v[64:67], v254 offset:6144
    ds_read_b128 v[68:71], v255 offset:7168
    s_mov_b64 exec, 1
    ds_add_u32 v3, v4 offset:20
    s_mov_b64 exec, -1
    v_mfma_f32_32x32x16_bf16 v[232:247], v[92:95], v[188:191], v[232:247]
    v_mfma_f32_32x32x16_bf16 v[232:247], v[96:99], v[192:195], v[232:247]
    v_mfma_f32_32x32x16_bf16 v[232:247], v[100:103], v[196:199], v[232:247]
    s_waitcnt lgkmcnt(15)
    v_mfma_f32_32x32x16_bf16 v[232:247], v[104:107], v[200:203], v[232:247]
    ds_read_b32 v5, v3 offset:208
    ds_read_b128 v[72:75], v20
    ds_read_b128 v[76:79], v21
    v_mfma_f32_32x32x16_bf16 v[232:247], v[108:111], v[204:207], v[232:247]
    ds_read_b128 v[80:83], v22
    ds_read_b128 v[84:87], v23
    v_mfma_f32_32x32x16_bf16 v[232:247], v[112:115], v[208:211], v[232:247]
    ds_read_b128 v[88:91], v24
    ds_read_b128 v[92:95], v25
    v_mfma_f32_32x32x16_bf16 v[232:247], v[116:119], v[212:215], v[232:247]
    ds_read_b128 v[96:99], v26
    ds_read_b128 v[100:103], v27
    v_mfma_f32_32x32x16_bf16 v[232:247], v[120:123], v[216:219], v[232:247]
    s_xor_b32 s8, s3, 1
    s_lshl_b32 s8, s8, 6
    v_add_u32 v17, s8, v15
    v_mfma_f32_32x32x16_bf16 v[232:247], v[124:127], v[220:223], v[232:247]
    s_xor_b32 s8, s3, 2
    s_lshl_b32 s8, s8, 6
    v_add_u32 v18, s8, v15
    v_mfma_f32_32x32x16_bf16 v[232:247], v[128:131], v[224:227], v[232:247]
    s_xor_b32 s8, s3, 3
    s_lshl_b32 s8, s8, 6
    v_add_u32 v15, s8, v15
    v_mfma_f32_32x32x16_bf16 v[232:247], v[132:135], v[228:231], v[232:247]
    s_waitcnt lgkmcnt(0)
    v_cmp_le_u32 vcc, 2, v5
    s_cbranch_vccz L_C3
L_C3D:
    v_mfma_f32_32x32x16_bf16 v[232:247], v[72:75], v[40:43], v[232:247]
    ds_read_b64_tr_b16 v[136:137], v28 offset:0
    ds_read_b64_tr_b16 v[138:139], v29 offset:2048
    ds_read_b64_tr_b16 v[168:169], v30 offset:0
    v_mfma_f32_32x32x16_bf16 v[232:247], v[76:79], v[44:47], v[232:247]
    ds_read_b64_tr_b16 v[170:171], v31 offset:2048
    ds_read_b64_tr_b16 v[140:141], v28 offset:4096
    ds_read_b64_tr_b16 v[142:143], v29 offset:6144
    v_mfma_f32_32x32x16_bf16 v[232:247], v[80:83], v[48:51], v[232:247]
    ds_read_b64_tr_b16 v[172:173], v30 offset:4096
    ds_read_b64_tr_b16 v[174:175], v31 offset:6144
    v_xor_b32 v28, 0x2000, v28
    ds_read_b64_tr_b16 v[144:145], v28 offset:0
    v_mfma_f32_32x32x16_bf16 v[232:247], v[84:87], v[52:55], v[232:247]
    v_xor_b32 v29, 0x2000, v29
    ds_read_b64_tr_b16 v[146:147], v29 offset:2048
    v_xor_b32 v30, 0x2000, v30
    ds_read_b64_tr_b16 v[176:177], v30 offset:0
    v_xor_b32 v31, 0x2000, v31
    ds_read_b64_tr_b16 v[178:179], v31 offset:2048
    v_mfma_f32_32x32x16_bf16 v[232:247], v[88:91], v[56:59], v[232:247]
    ds_read_b64_tr_b16 v[148:149], v28 offset:4096
    ds_read_b64_tr_b16 v[150:151], v29 offset:6144
    ds_read_b64_tr_b16 v[180:181], v30 offset:4096
    v_mfma_f32_32x32x16_bf16 v[232:247], v[92:95], v[60:63], v[232:247]
    ds_read_b64_tr_b16 v[182:183], v31 offset:6144
    v_xor_b32 v28, 0x6000, v28
    ds_read_b64_tr_b16 v[152:153], v28 offset:0
    v_xor_b32 v29, 0x6000, v29
    ds_read_b64_tr_b16 v[154:155], v29 offset:2048
    v_mfma_f32_32x32x16_bf16 v[232:247], v[96:99], v[64:67], v[232:247]
    v_xor_b32 v30, 0x6000, v30
    ds_read_b64_tr_b16 v[184:185], v30 offset:0
    v_xor_b32 v31, 0x6000, v31
    ds_read_b64_tr_b16 v[186:187], v31 offset:2048
    ds_read_b64_tr_b16 v[156:157], v28 offset:4096
    v_mfma_f32_32x32x16_bf16 v[232:247], v[100:103], v[68:71], v[232:247]
    ds_read_b64_tr_b16 v[158:159], v29 offset:6144
    ds_read_b64_tr_b16 v[188:189], v30 offset:4096
    ds_read_b64_tr_b16 v[190:191], v31 offset:6144
    v_xor_b32 v28, 0x2000, v28
    ds_read_b64_tr_b16 v[160:161], v28 offset:0
    v_xor_b32 v29, 0x2000, v29
    ds_read_b64_tr_b16 v[162:163], v29 offset:2048
    v_xor_b32 v30, 0x2000, v30
    ds_read_b64_tr_b16 v[192:193], v30 offset:0
    v_xor_b32 v31, 0x2000, v31
    ds_read_b64_tr_b16 v[194:195], v31 offset:2048
    s_nop 0
    v_max3_f32 v6, v232, v233, v234
    v_max3_f32 v7, v235, v236, v237
    v_max3_f32 v6, v6, v238, v239
    v_max3_f32 v7, v7, v240, v241
    v_max3_f32 v6, v6, v242, v243
    v_max3_f32 v7, v7, v244, v245
    v_max3_f32 v6, v6, v246, v247
    v_max_f32 v6, v6, v7
    ds_max_f32 v16, v6 offset:64
    s_mov_b64 exec, 1
    ds_add_u32 v3, v4 offset:12
    s_mov_b64 exec, -1
    v_pk_add_f32 v[232:233], v[232:233], v[6:7] op_sel_hi:[1,0] neg_lo:[0,1] neg_hi:[0,1]
    v_pk_add_f32 v[234:235], v[234:235], v[6:7] op_sel_hi:[1,0] neg_lo:[0,1] neg_hi:[0,1]
    v_exp_f32 v232, v232
    v_exp_f32 v233, v233
    v_exp_f32 v234, v234
    v_exp_f32 v235, v235
    v_pk_add_f32 v[236:237], v[236:237], v[6:7] op_sel_hi:[1,0] neg_lo:[0,1] neg_hi:[0,1]
    v_pk_add_f32 v[238:239], v[238:239], v[6:7] op_sel_hi:[1,0] neg_lo:[0,1] neg_hi:[0,1]
    v_exp_f32 v236, v236
    v_exp_f32 v237, v237
    v_exp_f32 v238, v238
    v_exp_f32 v239, v239
    v_pk_add_f32 v[240:241], v[240:241], v[6:7] op_sel_hi:[1,0] neg_lo:[0,1] neg_hi:[0,1]
    v_pk_add_f32 v[242:243], v[242:243], v[6:7] op_sel_hi:[1,0] neg_lo:[0,1] neg_hi:[0,1]
    ds_read_b32 v5, v3 offset:12
    ds_read_b32 v20, v16 offset:64
    v_exp_f32 v240, v240
    v_exp_f32 v241, v241
    v_exp_f32 v242, v242
    v_exp_f32 v243, v243
    v_pk_add_f32 v[244:245], v[244:245], v[6:7] op_sel_hi:[1,0] neg_lo:[0,1] neg_hi:[0,1]
    v_pk_add_f32 v[246:247], v[246:247], v[6:7] op_sel_hi:[1,0] neg_lo:[0,1] neg_hi:[0,1]
    v_exp_f32 v244, v244
    v_exp_f32 v245, v245
    v_exp_f32 v246, v246
    v_exp_f32 v247, v247
    s_waitcnt lgkmcnt(0)
    v_cmp_le_u32 vcc, 6, v5
    s_cbranch_vccz L_MX
L_MXD:
    v_sub_f32 v20, v6, v20
    v_exp_f32 v20, v20
    ds_read_b64_tr_b16 v[164:165], v28 offset:4096
    ds_read_b64_tr_b16 v[166:167], v29 offset:6144
    ds_read_b64_tr_b16 v[196:197], v30 offset:4096
    ds_read_b64_tr_b16 v[198:199], v31 offset:6144
    v_pk_mul_f32 v[232:233], v[232:233], v[20:21] op_sel_hi:[1,0]
    v_pk_mul_f32 v[234:235], v[234:235], v[20:21] op_sel_hi:[1,0]
    v_pk_mul_f32 v[236:237], v[236:237], v[20:21] op_sel_hi:[1,0]
    v_pk_mul_f32 v[238:239], v[238:239], v[20:21] op_sel_hi:[1,0]
    v_cvt_pk_bf16_f32 v200, v232, v233
    v_cvt_pk_bf16_f32 v201, v234, v235
    v_cvt_pk_bf16_f32 v202, v236, v237
    v_cvt_pk_bf16_f32 v203, v238, v239
    ds_write_b128 v14, v[200:203] offset:0
    v_pk_mul_f32 v[240:241], v[240:241], v[20:21] op_sel_hi:[1,0]
    v_pk_mul_f32 v[242:243], v[242:243], v[20:21] op_sel_hi:[1,0]
    v_pk_mul_f32 v[244:245], v[244:245], v[20:21] op_sel_hi:[1,0]
    v_pk_mul_f32 v[246:247], v[246:247], v[20:21] op_sel_hi:[1,0]
    v_cvt_pk_bf16_f32 v204, v240, v241
    v_cvt_pk_bf16_f32 v205, v242, v243
    v_cvt_pk_bf16_f32 v206, v244, v245
    v_cvt_pk_bf16_f32 v207, v246, v247
    ds_write_b128 v14, v[204:207] offset:32
    s_mov_b64 exec, 1
    ds_add_u32 v3, v4 offset:16
    s_mov_b64 exec, -1
    v_mfma_f32_32x32x16_bf16 v[104:119], v[200:203], v[136:139], 0
    v_pk_add_f32 v[232:233], v[232:233], v[240:241]
    v_pk_add_f32 v[234:235], v[234:235], v[242:243]
    v_pk_add_f32 v[236:237], v[236:237], v[244:245]
    v_pk_add_f32 v[238:239], v[238:239], v[246:247]
    v_mfma_f32_32x32x16_bf16 v[120:135], v[200:203], v[168:171], 0
    ds_read_b32 v5, v3 offset:16
    ds_read_b128 v[208:211], v17 offset:0
    ds_read_b128 v[212:215], v17 offset:32
    ds_read_b128 v[216:219], v18 offset:0
    ds_read_b128 v[220:223], v18 offset:32
    ds_read_b128 v[224:227], v15 offset:0
    ds_read_b128 v[228:231], v15 offset:32
    v_mfma_f32_32x32x16_bf16 v[104:119], v[204:207], v[140:143], v[104:119]
    v_pk_add_f32 v[232:233], v[232:233], v[236:237]
    v_pk_add_f32 v[234:235], v[234:235], v[238:239]
    v_pk_add_f32 v[232:233], v[232:233], v[234:235]
    v_mfma_f32_32x32x16_bf16 v[120:135], v[204:207], v[172:175], v[120:135]
    s_nop 0
    v_permlane32_swap_b32 v232, v233
    v_add_f32 v232, v232, v233
    ds_write_b32 v19, v232
    s_mov_b64 exec, 1
    ds_add_u32 v3, v4 offset:56
    s_mov_b64 exec, -1
    s_waitcnt lgkmcnt(7)
    v_cmp_le_u32 vcc, 4, v5
    s_cbranch_vccz L_PW
L_PWD:
    v_mfma_f32_32x32x16_bf16 v[104:119], v[208:211], v[144:147], v[104:119]
    ds_read_b64_tr_b16 v[40:41], v32 offset:0
    ds_read_b64_tr_b16 v[42:43], v33 offset:2048
    ds_read_b64_tr_b16 v[72:73], v34 offset:0
    v_mfma_f32_32x32x16_bf16 v[120:135], v[208:211], v[176:179], v[120:135]
    ds_read_b64_tr_b16 v[74:75], v35 offset:2048
    ds_read_b64_tr_b16 v[44:45], v32 offset:4096
    ds_read_b64_tr_b16 v[46:47], v33 offset:6144
    s_waitcnt lgkmcnt(12)
    v_mfma_f32_32x32x16_bf16 v[104:119], v[212:215], v[148:151], v[104:119]
    ds_read_b64_tr_b16 v[76:77], v34 offset:4096
    ds_read_b64_tr_b16 v[78:79], v35 offset:6144
    v_xor_b32 v32, 0x2000, v32
    ds_read_b64_tr_b16 v[48:49], v32 offset:0
    v_mfma_f32_32x32x16_bf16 v[120:135], v[212:215], v[180:183], v[120:135]
    v_xor_b32 v33, 0x2000, v33
    ds_read_b64_tr_b16 v[50:51], v33 offset:2048
    v_xor_b32 v34, 0x2000, v34
    ds_read_b64_tr_b16 v[80:81], v34 offset:0
    v_xor_b32 v35, 0x2000, v35
    ds_read_b64_tr_b16 v[82:83], v35 offset:2048
    v_mfma_f32_32x32x16_bf16 v[104:119], v[216:219], v[152:155], v[104:119]
    ds_read_b64_tr_b16 v[52:53], v32 offset:4096
    ds_read_b64_tr_b16 v[54:55], v33 offset:6144
    ds_read_b64_tr_b16 v[84:85], v34 offset:4096
    v_mfma_f32_32x32x16_bf16 v[120:135], v[216:219], v[184:187], v[120:135]
    ds_read_b64_tr_b16 v[86:87], v35 offset:6144
    v_xor_b32 v32, 0x6000, v32
    ds_read_b64_tr_b16 v[56:57], v32 offset:0
    v_xor_b32 v33, 0x6000, v33
    ds_read_b64_tr_b16 v[58:59], v33 offset:2048
    v_mfma_f32_32x32x16_bf16 v[104:119], v[220:223], v[156:159], v[104:119]
    v_xor_b32 v34, 0x6000, v34
    ds_read_b64_tr_b16 v[88:89], v34 offset:0
    v_xor_b32 v35, 0x6000, v35
    ds_read_b64_tr_b16 v[90:91], v35 offset:2048
    ds_read_b64_tr_b16 v[60:61], v32 offset:4096
    v_mfma_f32_32x32x16_bf16 v[120:135], v[220:223], v[188:191], v[120:135]
    ds_read_b64_tr_b16 v[62:63], v33 offset:6144
    ds_read_b64_tr_b16 v[92:93], v34 offset:4096
    ds_read_b64_tr_b16 v[94:95], v35 offset:6144
    v_mfma_f32_32x32x16_bf16 v[104:119], v[224:227], v[160:163], v[104:119]
    v_xor_b32 v32, 0x2000, v32
    ds_read_b64_tr_b16 v[64:65], v32 offset:0
    v_xor_b32 v33, 0x2000, v33
    ds_read_b64_tr_b16 v[66:67], v33 offset:2048
    v_xor_b32 v34, 0x2000, v34
    ds_read_b64_tr_b16 v[96:97], v34 offset:0
    v_mfma_f32_32x32x16_bf16 v[120:135], v[224:227], v[192:195], v[120:135]
    v_xor_b32 v35, 0x2000, v35
    ds_read_b64_tr_b16 v[98:99], v35 offset:2048
    ds_read_b64_tr_b16 v[68:69], v32 offset:4096
    ds_read_b64_tr_b16 v[70:71], v33 offset:6144
    v_mfma_f32_32x32x16_bf16 v[104:119], v[228:231], v[164:167], v[104:119]
    ds_read_b64_tr_b16 v[100:101], v34 offset:4096
    ds_read_b64_tr_b16 v[102:103], v35 offset:6144
    v_mfma_f32_32x32x16_bf16 v[120:135], v[228:231], v[196:199], v[120:135]
    s_waitcnt lgkmcnt(0)
    v_mfma_f32_32x32x16_bf16 v[136:151], v[200:203], v[40:43], 0
    v_mfma_f32_32x32x16_bf16 v[152:167], v[200:203], v[72:75], 0
    s_nop 8
    v_perm_b32 v104, v120, v104, s29
    v_and_or_b32 v104, v104, s41, v37
    s_add_u32 s10, s12, 0
    buffer_store_dword v104, v36, s[44:47], s10 offen sc1
    v_mfma_f32_32x32x16_bf16 v[136:151], v[204:207], v[44:47], v[136:151]
    v_perm_b32 v105, v121, v105, s29
    v_and_or_b32 v105, v105, s41, v37
    s_add_u32 s10, s12, 131072
    buffer_store_dword v105, v36, s[44:47], s10 offen sc1
    v_mfma_f32_32x32x16_bf16 v[152:167], v[204:207], v[76:79], v[152:167]
    v_perm_b32 v106, v122, v106, s29
    v_and_or_b32 v106, v106, s41, v37
    s_add_u32 s10, s12, 262144
    buffer_store_dword v106, v36, s[44:47], s10 offen sc1
    v_mfma_f32_32x32x16_bf16 v[136:151], v[208:211], v[48:51], v[136:151]
    v_perm_b32 v107, v123, v107, s29
    v_and_or_b32 v107, v107, s41, v37
    s_add_u32 s10, s12, 393216
    buffer_store_dword v107, v36, s[44:47], s10 offen sc1
    v_mfma_f32_32x32x16_bf16 v[152:167], v[208:211], v[80:83], v[152:167]
    v_perm_b32 v108, v124, v108, s29
    v_and_or_b32 v108, v108, s41, v37
    s_add_u32 s10, s12, 1048576
    buffer_store_dword v108, v36, s[44:47], s10 offen sc1
    v_mfma_f32_32x32x16_bf16 v[136:151], v[212:215], v[52:55], v[136:151]
    v_perm_b32 v109, v125, v109, s29
    v_and_or_b32 v109, v109, s41, v37
    s_add_u32 s10, s12, 1179648
    buffer_store_dword v109, v36, s[44:47], s10 offen sc1
    v_mfma_f32_32x32x16_bf16 v[152:167], v[212:215], v[84:87], v[152:167]
    v_perm_b32 v110, v126, v110, s29
    v_and_or_b32 v110, v110, s41, v37
    s_add_u32 s10, s12, 1310720
    buffer_store_dword v110, v36, s[44:47], s10 offen sc1
    v_mfma_f32_32x32x16_bf16 v[136:151], v[216:219], v[56:59], v[136:151]
    v_perm_b32 v111, v127, v111, s29
    v_and_or_b32 v111, v111, s41, v37
    s_add_u32 s10, s12, 1441792
    buffer_store_dword v111, v36, s[44:47], s10 offen sc1
    v_mfma_f32_32x32x16_bf16 v[152:167], v[216:219], v[88:91], v[152:167]
    v_perm_b32 v112, v128, v112, s29
    v_and_or_b32 v112, v112, s41, v37
    s_add_u32 s10, s12, 2097152
    buffer_store_dword v112, v36, s[44:47], s10 offen sc1
    v_mfma_f32_32x32x16_bf16 v[136:151], v[220:223], v[60:63], v[136:151]
    v_perm_b32 v113, v129, v113, s29
    v_and_or_b32 v113, v113, s41, v37
    s_add_u32 s10, s12, 2228224
    buffer_store_dword v113, v36, s[44:47], s10 offen sc1
    v_mfma_f32_32x32x16_bf16 v[152:167], v[220:223], v[92:95], v[152:167]
    v_perm_b32 v114, v130, v114, s29
    v_and_or_b32 v114, v114, s41, v37
    s_add_u32 s10, s12, 2359296
    buffer_store_dword v114, v36, s[44:47], s10 offen sc1
    v_mfma_f32_32x32x16_bf16 v[136:151], v[224:227], v[64:67], v[136:151]
    v_perm_b32 v115, v131, v115, s29
    v_and_or_b32 v115, v115, s41, v37
    s_add_u32 s10, s12, 2490368
    buffer_store_dword v115, v36, s[44:47], s10 offen sc1
    v_mfma_f32_32x32x16_bf16 v[152:167], v[224:227], v[96:99], v[152:167]
    v_perm_b32 v116, v132, v116, s29
    v_and_or_b32 v116, v116, s41, v37
    s_add_u32 s10, s12, 3145728
    buffer_store_dword v116, v36, s[44:47], s10 offen sc1
    v_mfma_f32_32x32x16_bf16 v[136:151], v[228:231], v[68:71], v[136:151]
    v_perm_b32 v117, v133, v117, s29
    v_and_or_b32 v117, v117, s41, v37
    s_add_u32 s10, s12, 3276800
    buffer_store_dword v117, v36, s[44:47], s10 offen sc1
    v_mfma_f32_32x32x16_bf16 v[152:167], v[228:231], v[100:103], v[152:167]
    v_perm_b32 v118, v134, v118, s29
    v_and_or_b32 v118, v118, s41, v37
    s_add_u32 s10, s12, 3407872
    buffer_store_dword v118, v36, s[44:47], s10 offen sc1
    v_perm_b32 v119, v135, v119, s29
    v_and_or_b32 v119, v119, s41, v37
    s_add_u32 s10, s12, 3538944
    buffer_store_dword v119, v36, s[44:47], s10 offen sc1
    s_nop 7
L_HLE:
    v_perm_b32 v136, v152, v136, s29
    v_and_or_b32 v136, v136, s41, v37
    s_add_u32 s10, s12, 128
    buffer_store_dword v136, v36, s[44:47], s10 offen sc1
    v_perm_b32 v137, v153, v137, s29
    v_and_or_b32 v137, v137, s41, v37
    s_add_u32 s10, s12, 131200
    buffer_store_dword v137, v36, s[44:47], s10 offen sc1
    v_perm_b32 v138, v154, v138, s29
    v_and_or_b32 v138, v138, s41, v37
    s_add_u32 s10, s12, 262272
    buffer_store_dword v138, v36, s[44:47], s10 offen sc1
    v_perm_b32 v139, v155, v139, s29
    v_and_or_b32 v139, v139, s41, v37
    s_add_u32 s10, s12, 393344
    buffer_store_dword v139, v36, s[44:47], s10 offen sc1
    v_perm_b32 v140, v156, v140, s29
    v_and_or_b32 v140, v140, s41, v37
    s_add_u32 s10, s12, 1048704
    buffer_store_dword v140, v36, s[44:47], s10 offen sc1
    v_perm_b32 v141, v157, v141, s29
    v_and_or_b32 v141, v141, s41, v37
    s_add_u32 s10, s12, 1179776
    buffer_store_dword v141, v36, s[44:47], s10 offen sc1
    v_perm_b32 v142, v158, v142, s29
    v_and_or_b32 v142, v142, s41, v37
    s_add_u32 s10, s12, 1310848
    buffer_store_dword v142, v36, s[44:47], s10 offen sc1
    v_perm_b32 v143, v159, v143, s29
    v_and_or_b32 v143, v143, s41, v37
    s_add_u32 s10, s12, 1441920
    buffer_store_dword v143, v36, s[44:47], s10 offen sc1
    v_perm_b32 v144, v160, v144, s29
    v_and_or_b32 v144, v144, s41, v37
    s_add_u32 s10, s12, 2097280
    buffer_store_dword v144, v36, s[44:47], s10 offen sc1
    v_perm_b32 v145, v161, v145, s29
    v_and_or_b32 v145, v145, s41, v37
    s_add_u32 s10, s12, 2228352
    buffer_store_dword v145, v36, s[44:47], s10 offen sc1
    v_perm_b32 v146, v162, v146, s29
    v_and_or_b32 v146, v146, s41, v37
    s_add_u32 s10, s12, 2359424
    buffer_store_dword v146, v36, s[44:47], s10 offen sc1
    v_perm_b32 v147, v163, v147, s29
    v_and_or_b32 v147, v147, s41, v37
    s_add_u32 s10, s12, 2490496
    buffer_store_dword v147, v36, s[44:47], s10 offen sc1
    v_perm_b32 v148, v164, v148, s29
    v_and_or_b32 v148, v148, s41, v37
    s_add_u32 s10, s12, 3145856
    buffer_store_dword v148, v36, s[44:47], s10 offen sc1
    v_perm_b32 v149, v165, v149, s29
    v_and_or_b32 v149, v149, s41, v37
    s_add_u32 s10, s12, 3276928
    buffer_store_dword v149, v36, s[44:47], s10 offen sc1
    v_perm_b32 v150, v166, v150, s29
    v_and_or_b32 v150, v150, s41, v37
    s_add_u32 s10, s12, 3408000
    buffer_store_dword v150, v36, s[44:47], s10 offen sc1
    v_perm_b32 v151, v167, v151, s29
    v_and_or_b32 v151, v151, s41, v37
    s_add_u32 s10, s12, 3539072
    buffer_store_dword v151, v36, s[44:47], s10 offen sc1
    s_setprio 0
    s_waitcnt vmcnt(31)
    s_mov_b64 exec, 1
    ds_add_u32 v3, v4 offset:44
    s_mov_b64 exec, -1
    s_cmp_lt_u32 s71, 27
    s_cbranch_scc0 L_EXIT
    s_lshl_b32 s8, s3, 12
    s_add_u32 s13, s8, 65536
    s_mov_b32 s60, 0x00ff00ff
    s_mov_b32 s61, 0x00ff00ff
    s_lshl_b32 s8, s3, 2
    s_add_u32 s8, s8, 81920
    v_lshl_add_u32 v246, v0, 4, s8
    v_lshrrev_b32 v5, 2, v0
    v_and_b32 v6, 3, v0
    v_lshlrev_b32 v6, 4, v6
    v_lshl_add_u32 v245, v5, 7, v6
    s_lshl_b32 s8, s4, 13
    s_lshl_b32 s9, s3, 11
    s_add_u32 s8, s8, s9
    s_add_u32 s62, s8, 393216
    v_mul_u32_u24 v21, 80, v5
    v_add3_u32 v21, v21, v6, s13
    v_mul_u32_u24 v22, 80, v1
    v_lshl_add_u32 v22, v2, 4, v22
    v_add_u32 v22, s13, v22
    s_mul_i32 s8, s3, 5
    v_add_u32 v7, s8, v13
    v_and_b32 v5, 7, v5
    v_lshl_add_u32 v16, v5, 7, v6
    v_lshrrev_b32 v5, 1, v7
    v_lshl_add_u32 v16, v5, 10, v16
    v_and_b32 v5, 1, v7
    v_lshl_add_u32 v16, v5, 6, v16
    s_mov_b32 s63, 458752
    s_mov_b32 s64, 499712
    s_mov_b32 s65, 458752
    s_mul_i32 s8, s3, 320
    v_lshl_add_u32 v6, v2, 4, s8
    v_and_b32 v247, 7, v0
    v_lshl_add_u32 v247, v2, 3, v247
    s_lshl_b32 s8, s15, 6
    v_lshl_add_u32 v7, v247, 1, s8
    v_cmp_eq_u32 vcc, 9, v1
    v_mov_b32 v5, 0x3f803f80
    s_nop 0
    v_cndmask_b32 v5, 0, v5, vcc
    v_mov_b32 v72, v5
    v_mov_b32 v73, v5
    v_mov_b32 v74, v5
    v_mov_b32 v75, v5
    v_mov_b32 v76, v5
    v_mov_b32 v77, v5
    v_mov_b32 v78, v5
    v_mov_b32 v79, v5
    v_mov_b32 v80, v5
    v_mov_b32 v81, v5
    v_mov_b32 v82, v5
    v_mov_b32 v83, v5
    v_mov_b32 v84, v5
    v_mov_b32 v85, v5
    v_mov_b32 v86, v5
    v_mov_b32 v87, v5
    v_mov_b32 v88, v5
    v_mov_b32 v89, v5
    v_mov_b32 v90, v5
    v_mov_b32 v91, v5
    global_load_ushort v12, v7, s[32:33]
    s_mov_b32 s8, 0x01000100
    s_mov_b32 s9, 0x01000100
    s_mov_b64 exec, s[8:9]
    global_load_dwordx4 v[72:75], v6, s[16:17] offset:0
    global_load_dwordx4 v[76:79], v6, s[16:17] offset:64
    global_load_dwordx4 v[80:83], v6, s[16:17] offset:128
    global_load_dwordx4 v[84:87], v6, s[16:17] offset:192
    global_load_dwordx4 v[88:91], v6, s[16:17] offset:256
    s_mov_b64 exec, -1
    v_lshrrev_b32 v5, 2, v1
    v_and_b32 v7, 3, v1
    v_lshl_add_u32 v5, v2, 3, v5
    s_mul_i32 s8, s3, 10240
    v_lshlrev_b32 v244, 6, v5
    v_lshl_add_u32 v244, v7, 3, v244
    v_add_u32 v244, s8, v244
    v_mul_u32_u24 v23, 1280, v5
    v_and_b32 v36, 1, v7
    v_lshl_add_u32 v23, v36, 3, v23
    v_add_u32 v23, 119296, v23
    v_and_b32 v36, 3, v5
    v_and_b32 v39, 8, v5
    v_lshl_add_u32 v36, v36, 1, v39
    v_lshrrev_b32 v39, 1, v7
    s_mul_i32 s8, s3, 20
    v_add_u32 v39, s8, v39
    v_add_u32 v40, 0, v39
    v_xor_b32 v40, v40, v36
    v_lshl_add_u32 v40, v40, 4, v23
    v_add_u32 v41, 2, v39
    v_xor_b32 v41, v41, v36
    v_lshl_add_u32 v41, v41, 4, v23
    v_add_u32 v42, 4, v39
    v_xor_b32 v42, v42, v36
    v_lshl_add_u32 v42, v42, 4, v23
    v_add_u32 v43, 6, v39
    v_xor_b32 v43, v43, v36
    v_lshl_add_u32 v43, v43, 4, v23
    v_add_u32 v44, 8, v39
    v_xor_b32 v44, v44, v36
    v_lshl_add_u32 v44, v44, 4, v23
    v_add_u32 v45, 10, v39
    v_xor_b32 v45, v45, v36
    v_lshl_add_u32 v45, v45, 4, v23
    v_add_u32 v46, 12, v39
    v_xor_b32 v46, v46, v36
    v_lshl_add_u32 v46, v46, 4, v23
    v_add_u32 v47, 14, v39
    v_xor_b32 v47, v47, v36
    v_lshl_add_u32 v47, v47, 4, v23
    v_add_u32 v48, 16, v39
    v_xor_b32 v48, v48, v36
    v_lshl_add_u32 v48, v48, 4, v23
    v_add_u32 v49, 18, v39
    v_xor_b32 v49, v49, v36
    v_lshl_add_u32 v49, v49, 4, v23
    v_lshlrev_b32 v14, 4, v1
    v_add_u32 v14, 81920, v14
    v_lshlrev_b32 v38, 4, v247
    v_add_u32 v38, 81920, v38
    s_mul_i32 s8, s3, 5*54*128
    s_lshl_b32 s9, s15, 7
    s_add_u32 s8, s8, s9
    s_add_u32 s52, s8, 499712
    v_mul_u32_u24 v17, 54*128, v13
    v_and_b32 v5, 31, v0
    v_lshl_add_u32 v17, v5, 2, v17
    s_add_u32 s53, s52, 2*54*128
    s_add_u32 s54, s52, 4*54*128
    s_add_u32 s55, s52, 138240
    s_add_u32 s56, s53, 138240
    s_add_u32 s57, s54, 138240
    v_cmp_gt_u32 vcc, 32, v0
    s_nop 1
    v_cndmask_b32 v15, 0, 1.0, vcc
    v_cmp_gt_u32 vcc, 9, v1
    s_nop 1
    v_cndmask_b32 v18, 0, 1.0, vcc
    v_mov_b32 v19, 0x3acccccd
LW_43:
    ds_read_b32 v5, v3 offset:216
    s_sub_u32 s70, s70, 1
    s_cbranch_scc1 L_EXIT
    s_waitcnt lgkmcnt(0)
    v_cmp_le_u32 vcc, 2, v5
    s_cbranch_vccnz LK_44
    s_sleep 1
    s_branch LW_43
LK_44:
    ds_read_b64_tr_b16 v[132:133], v40 offset:0
    ds_read_b64_tr_b16 v[134:135], v40 offset:5120
    ds_read_b64_tr_b16 v[138:139], v41 offset:0
    ds_read_b64_tr_b16 v[136:137], v41 offset:5120
    ds_read_b64_tr_b16 v[140:141], v42 offset:0
    ds_read_b64_tr_b16 v[142:143], v42 offset:5120
    ds_read_b64_tr_b16 v[146:147], v43 offset:0
    ds_read_b64_tr_b16 v[144:145], v43 offset:5120
    ds_read_b64_tr_b16 v[148:149], v44 offset:0
    ds_read_b64_tr_b16 v[150:151], v44 offset:5120
    ds_read_b64_tr_b16 v[154:155], v45 offset:0
    ds_read_b64_tr_b16 v[152:153], v45 offset:5120
    ds_read_b64_tr_b16 v[156:157], v46 offset:0
    ds_read_b64_tr_b16 v[158:159], v46 offset:5120
    ds_read_b64_tr_b16 v[162:163], v47 offset:0
    ds_read_b64_tr_b16 v[160:161], v47 offset:5120
    ds_read_b64_tr_b16 v[164:165], v48 offset:0
    ds_read_b64_tr_b16 v[166:167], v48 offset:5120
    ds_read_b64_tr_b16 v[170:171], v49 offset:0
    ds_read_b64_tr_b16 v[168:169], v49 offset:5120
LW_45:
    ds_read_b32 v5, v3 offset:212
    s_sub_u32 s70, s70, 1
    s_cbranch_scc1 L_EXIT
    s_waitcnt lgkmcnt(0)
    v_cmp_le_u32 vcc, 2, v5
    s_cbranch_vccnz LK_46
    s_sleep 1
    s_branch LW_45
LK_46:
    ds_read_b64_tr_b16 v[92:93], v244 offset:0
    ds_read_b64_tr_b16 v[94:95], v244 offset:256
    ds_read_b64_tr_b16 v[96:97], v244 offset:32
    ds_read_b64_tr_b16 v[98:99], v244 offset:288
    ds_read_b64_tr_b16 v[100:101], v244 offset:2048
    ds_read_b64_tr_b16 v[102:103], v244 offset:2304
    ds_read_b64_tr_b16 v[104:105], v244 offset:2080
    ds_read_b64_tr_b16 v[106:107], v244 offset:2336
    ds_read_b64_tr_b16 v[108:109], v244 offset:4096
    ds_read_b64_tr_b16 v[110:111], v244 offset:4352
    ds_read_b64_tr_b16 v[112:113], v244 offset:4128
    ds_read_b64_tr_b16 v[114:115], v244 offset:4384
    ds_read_b64_tr_b16 v[116:117], v244 offset:6144
    ds_read_b64_tr_b16 v[118:119], v244 offset:6400
    ds_read_b64_tr_b16 v[120:121], v244 offset:6176
    ds_read_b64_tr_b16 v[122:123], v244 offset:6432
    ds_read_b64_tr_b16 v[124:125], v244 offset:8192
    ds_read_b64_tr_b16 v[126:127], v244 offset:8448
    ds_read_b64_tr_b16 v[128:129], v244 offset:8224
    ds_read_b64_tr_b16 v[130:131], v244 offset:8480
    s_waitcnt vmcnt(0) lgkmcnt(0)
    v_lshlrev_b32 v12, 16, v12
    v_mov_b32 v180, 0
    v_mov_b32 v192, 0
    v_mov_b32 v181, 0
    v_mov_b32 v193, 0
    v_mov_b32 v182, 0
    v_mov_b32 v194, 0
    v_mov_b32 v183, 0
    v_mov_b32 v195, 0
    v_mfma_f32_16x16x32_bf16 v[24:27], v[72:75], v[92:95], 0
    v_mfma_f32_16x16x32_bf16 v[28:31], v[72:75], v[96:99], 0
    v_mfma_f32_16x16x32_bf16 v[24:27], v[76:79], v[100:103], v[24:27]
    v_mfma_f32_16x16x32_bf16 v[28:31], v[76:79], v[104:107], v[28:31]
    v_mfma_f32_16x16x32_bf16 v[24:27], v[80:83], v[108:111], v[24:27]
    v_mfma_f32_16x16x32_bf16 v[28:31], v[80:83], v[112:115], v[28:31]
    v_mfma_f32_16x16x32_bf16 v[24:27], v[84:87], v[116:119], v[24:27]
    v_mfma_f32_16x16x32_bf16 v[28:31], v[84:87], v[120:123], v[28:31]
    v_mfma_f32_16x16x32_bf16 v[24:27], v[88:91], v[124:127], v[24:27]
    v_mfma_f32_16x16x32_bf16 v[28:31], v[88:91], v[128:131], v[28:31]
    s_mov_b32 s8, 0
    s_mov_b32 s9, 0xffff
    s_mov_b64 exec, s[8:9]
    s_nop 3
    ds_write_b32 v246, v25 offset:256
    ds_write_b32 v246, v29 offset:512
    s_mov_b64 exec, 1
    ds_add_u32 v3, v4 offset:32
    s_mov_b64 exec, -1
LW_47:
    ds_read_b32 v5, v3 offset:40
    s_sub_u32 s70, s70, 1
    s_cbranch_scc1 L_EXIT
    s_waitcnt lgkmcnt(0)
    v_cmp_le_u32 vcc, 1, v5
    s_cbranch_vccz LW_47
    buffer_load_dwordx4 v[172:175], v16, s[44:47], s65 offen sc1
    buffer_load_dwordx4 v[176:179], v16, s[44:47], s65 offen offset:1024 sc1
    s_mov_b32 exec_hi, 0
    buffer_load_dwordx4 v[180:183], v16, s[44:47], s65 offen offset:2048 sc1
    s_mov_b32 exec_hi, -1
    s_add_u32 s65, s65, 10240
    s_cmp_eq_u32 s65, s64
    s_cselect_b32 s65, s63, s65
    s_sleep 4
V2_48:
    buffer_load_dwordx4 v[184:187], v16, s[44:47], s65 offen sc1
    buffer_load_dwordx4 v[188:191], v16, s[44:47], s65 offen offset:1024 sc1
    s_mov_b32 exec_hi, 0
    buffer_load_dwordx4 v[192:195], v16, s[44:47], s65 offen offset:2048 sc1
    s_mov_b32 exec_hi, -1
    s_add_u32 s65, s65, 10240
    s_cmp_eq_u32 s65, s64
    s_cselect_b32 s65, s63, s65
    s_sub_u32 s70, s70, 1
    s_cbranch_scc1 L_EXIT
    s_waitcnt vmcnt(3)
    ds_write_b128 v21, v[172:175] offset:0
    ds_write_b128 v21, v[176:179] offset:1280
    ds_write_b128 v21, v[180:183] offset:2560
    s_mov_b64 exec, s[60:61]
    ds_read_b128 v[72:75], v22 offset:0
    ds_read_b128 v[76:79], v22 offset:640
    ds_read_b128 v[80:83], v22 offset:1280
    ds_read_b128 v[84:87], v22 offset:1920
    ds_read_b128 v[88:91], v22 offset:2560
    s_mov_b64 exec, -1
    v_max3_u32 v5, v172, v173, v174
    v_max3_u32 v5, v5, v175, v176
    v_max3_u32 v5, v5, v177, v178
    v_max3_u32 v5, v5, v179, v180
    v_max3_u32 v5, v5, v181, v182
    v_max_u32 v5, v5, v183
    v_cmp_eq_u32 vcc, -1, v5
    s_cbranch_vccz VD_49
    buffer_load_dwordx4 v[172:175], v16, s[44:47], s65 offen sc1
    buffer_load_dwordx4 v[176:179], v16, s[44:47], s65 offen offset:1024 sc1
    s_mov_b32 exec_hi, 0
    buffer_load_dwordx4 v[180:183], v16, s[44:47], s65 offen offset:2048 sc1
    s_mov_b32 exec_hi, -1
    s_add_u32 s65, s65, 10240
    s_cmp_eq_u32 s65, s64
    s_cselect_b32 s65, s63, s65
    s_waitcnt vmcnt(3)
    ds_write_b128 v21, v[184:187] offset:0
    ds_write_b128 v21, v[188:191] offset:1280
    ds_write_b128 v21, v[192:195] offset:2560
    s_mov_b64 exec, s[60:61]
    ds_read_b128 v[72:75], v22 offset:0
    ds_read_b128 v[76:79], v22 offset:640
    ds_read_b128 v[80:83], v22 offset:1280
    ds_read_b128 v[84:87], v22 offset:1920
    ds_read_b128 v[88:91], v22 offset:2560
    s_mov_b64 exec, -1
    v_max3_u32 v5, v184, v185, v186
    v_max3_u32 v5, v5, v187, v188
    v_max3_u32 v5, v5, v189, v190
    v_max3_u32 v5, v5, v191, v192
    v_max3_u32 v5, v5, v193, v194
    v_max_u32 v5, v5, v195
    v_cmp_eq_u32 vcc, -1, v5
    s_cbranch_vccnz V2_48
VD_49:
    s_waitcnt lgkmcnt(4)
    v_mfma_f32_16x16x32_bf16 v[24:27], v[72:75], v[92:95], 0
    v_mfma_f32_16x16x32_bf16 v[28:31], v[72:75], v[96:99], 0
    v_mfma_f32_16x16x32_bf16 v[32:35], v[72:75], v[72:75], 0
    s_waitcnt lgkmcnt(3)
    v_mfma_f32_16x16x32_bf16 v[24:27], v[76:79], v[100:103], v[24:27]
    v_mfma_f32_16x16x32_bf16 v[28:31], v[76:79], v[104:107], v[28:31]
    v_mfma_f32_16x16x32_bf16 v[32:35], v[76:79], v[76:79], v[32:35]
    s_waitcnt lgkmcnt(2)
    v_mfma_f32_16x16x32_bf16 v[24:27], v[80:83], v[108:111], v[24:27]
    v_mfma_f32_16x16x32_bf16 v[28:31], v[80:83], v[112:115], v[28:31]
    v_mfma_f32_16x16x32_bf16 v[32:35], v[80:83], v[80:83], v[32:35]
    s_waitcnt lgkmcnt(1)
    v_mfma_f32_16x16x32_bf16 v[24:27], v[84:87], v[116:119], v[24:27]
    v_mfma_f32_16x16x32_bf16 v[28:31], v[84:87], v[120:123], v[28:31]
    v_mfma_f32_16x16x32_bf16 v[32:35], v[84:87], v[84:87], v[32:35]
    s_waitcnt lgkmcnt(0)
    v_mfma_f32_16x16x32_bf16 v[24:27], v[88:91], v[124:127], v[24:27]
    v_mfma_f32_16x16x32_bf16 v[28:31], v[88:91], v[128:131], v[28:31]
    v_mfma_f32_16x16x32_bf16 v[32:35], v[88:91], v[88:91], v[32:35]
    v_mov_b32 v37, 0
    s_nop 4
    v_add_f32 v26, v26, v27
    v_add_f32 v26, v26, v25
    v_fmac_f32 v24, v26, v15
    v_add_f32 v30, v30, v31
    v_add_f32 v30, v30, v29
    v_fmac_f32 v28, v30, v15
    v_add_f32 v34, v34, v35
    v_add_f32 v34, v34, v33
    v_fmac_f32 v32, v34, v15
    s_nop 1
    v_permlane32_swap_b32 v24, v32
    v_permlane32_swap_b32 v28, v37
    v_add_f32 v24, v24, v32
    v_add_f32 v28, v28, v37
    s_nop 1
    v_permlane16_swap_b32 v24, v28
    v_add_f32 v24, v24, v28
    s_mov_b32 exec_hi, 0xffff
    ds_write_b32 v246, v24
    s_mov_b64 exec, 1
    ds_add_u32 v3, v4 offset:36
    s_mov_b64 exec, -1
LW_50:
    ds_read_b32 v5, v3 offset:36
    ds_read_b128 v[24:27], v14 offset:512
    ds_read_b128 v[28:31], v38
    ds_read_b128 v[52:55], v38 offset:768
    s_sub_u32 s70, s70, 1
    s_cbranch_scc1 L_EXIT
    s_waitcnt lgkmcnt(0)
    v_cmp_le_u32 vcc, 4, v5
    s_cbranch_vccz LW_50
    v_add_f32 v24, v24, v25
    v_add_f32 v26, v26, v27
    v_add_f32 v28, v28, v29
    v_add_f32 v24, v24, v26
    v_add_f32 v30, v30, v31
    v_mul_f32 v25, v24, v18
    v_mul_f32_dpp v26, v24, v19 row_newbcast:9 row_mask:0xf bank_mask:0xf
    v_add_f32 v28, v28, v30
    v_add_f32_dpp v25, v25, v25 quad_perm:[1,0,3,2] row_mask:0xf bank_mask:0xf
    v_add_f32 v52, v52, v53
    s_nop 0
    v_add_f32_dpp v25, v25, v25 quad_perm:[2,3,0,1] row_mask:0xf bank_mask:0xf
    v_add_f32 v54, v54, v55
    s_nop 0
    v_add_f32_dpp v25, v25, v25 row_half_mirror row_mask:0xf bank_mask:0xf
    v_add_f32 v20, v52, v54
    s_nop 0
    v_add_f32_dpp v25, v25, v25 row_mirror row_mask:0xf bank_mask:0xf
    v_mul_f32 v27, v26, v26
    v_fma_f32 v25, v25, v19, -v27
    v_max_f32 v25, 0, v25
    v_cvt_pk_bf16_f32 v27, v25, v25
    v_and_b32 v25, 0xffff0000, v27
    v_add_f32 v25, 0x3727c5ac, v25
    v_cvt_pk_bf16_f32 v27, v25, v25
    v_and_b32 v25, 0xffff0000, v27
    v_sqrt_f32 v25, v25
    v_cvt_pk_bf16_f32 v27, v26, v26
    v_and_b32 v26, 0xffff0000, v27
    v_cvt_pk_bf16_f32 v27, v25, v25
    v_and_b32 v25, 0xffff0000, v27
    v_rcp_f32 v25, v25
    v_fma_f32 v28, -v26, v20, v28
    v_fma_f32 v28, v28, v25, v12
    v_max_f32 v28, 0, v28
    v_mul_f32 v28, v28, v28
    s_nop 1
    v_mov_b32_dpp v29, v28 quad_perm:[1,1,3,3] row_mask:0xf bank_mask:0xf
    v_cvt_pk_bf16_f32 v32, v28, v29
    s_nop 1
    v_mov_b32_dpp v33, v32 row_ror:14 row_mask:0xf bank_mask:0xf
    v_mov_b32_dpp v34, v32 row_ror:12 row_mask:0xf bank_mask:0xf
    v_mov_b32_dpp v35, v32 row_ror:10 row_mask:0xf bank_mask:0xf
    s_nop 1
    v_mfma_f32_16x16x32_bf16 v[200:203], v[32:35], v[132:135], 0
    v_mfma_f32_16x16x32_bf16 v[204:207], v[32:35], v[136:139], 0
    v_mfma_f32_16x16x32_bf16 v[208:211], v[32:35], v[140:143], 0
    v_mfma_f32_16x16x32_bf16 v[212:215], v[32:35], v[144:147], 0
    v_mfma_f32_16x16x32_bf16 v[216:219], v[32:35], v[148:151], 0
    v_mfma_f32_16x16x32_bf16 v[220:223], v[32:35], v[152:155], 0
    v_mfma_f32_16x16x32_bf16 v[224:227], v[32:35], v[156:159], 0
    v_mfma_f32_16x16x32_bf16 v[228:231], v[32:35], v[160:163], 0
    v_mfma_f32_16x16x32_bf16 v[232:235], v[32:35], v[164:167], 0
    v_mfma_f32_16x16x32_bf16 v[236:239], v[32:35], v[168:171], 0
    v_mov_b32_dpp v200, v204 quad_perm:[0,1,2,3] row_mask:0x2 bank_mask:0xf
    s_nop 1
    v_mov_b32_dpp v200, v208 quad_perm:[0,1,2,3] row_mask:0x4 bank_mask:0xf
    s_nop 1
    v_mov_b32_dpp v200, v212 quad_perm:[0,1,2,3] row_mask:0x8 bank_mask:0xf
    v_min_u32 v200, -2, v200
    buffer_store_dword v200, v17, s[44:47], s52 offen sc1
    v_mov_b32_dpp v216, v220 quad_perm:[0,1,2,3] row_mask:0x2 bank_mask:0xf
    s_nop 1
    v_mov_b32_dpp v216, v224 quad_perm:[0,1,2,3] row_mask:0x4 bank_mask:0xf
    s_nop 1
    v_mov_b32_dpp v216, v228 quad_perm:[0,1,2,3] row_mask:0x8 bank_mask:0xf
    v_min_u32 v216, -2, v216
    buffer_store_dword v216, v17, s[44:47], s53 offen sc1
    v_mov_b32_dpp v232, v236 quad_perm:[0,1,2,3] row_mask:0x2 bank_mask:0xf
    v_min_u32 v232, -2, v232
    s_mov_b32 exec_hi, 0
    buffer_store_dword v232, v17, s[44:47], s54 offen sc1
    buffer_store_dword v232, v17, s[44:47], s57 offen sc1
    s_mov_b32 exec_hi, -1
    buffer_store_dword v200, v17, s[44:47], s55 offen sc1
    buffer_store_dword v216, v17, s[44:47], s56 offen sc1
    s_branch L_EXIT
L_C2B:
LW_51:
    ds_read_b32 v5, v3 offset:204
    s_sub_u32 s70, s70, 1
    s_cbranch_scc1 L_EXIT
    s_waitcnt lgkmcnt(0)
    v_cmp_le_u32 vcc, 2, v5
    s_cbranch_vccz LW_51
    ds_read_b128 v[104:107], v20
    ds_read_b128 v[108:111], v21
    ds_read_b128 v[112:115], v22
    ds_read_b128 v[116:119], v23
    ds_read_b128 v[120:123], v24
    ds_read_b128 v[124:127], v25
    ds_read_b128 v[128:131], v26
    ds_read_b128 v[132:135], v27
    v_xor_b32 v20, 0x8000, v20
    v_xor_b32 v21, 0x8000, v21
    v_xor_b32 v22, 0x8000, v22
    v_xor_b32 v23, 0x8000, v23
    v_xor_b32 v24, 0x8000, v24
    v_xor_b32 v25, 0x8000, v25
    v_xor_b32 v26, 0x8000, v26
    v_xor_b32 v27, 0x8000, v27
    s_branch L_C2C
L_MX:
LW_52:
    ds_read_b32 v5, v3 offset:12
    ds_read_b32 v20, v16 offset:64
    s_sub_u32 s70, s70, 1
    s_cbranch_scc1 L_EXIT
    s_waitcnt lgkmcnt(0)
    v_cmp_le_u32 vcc, 6, v5
    s_cbranch_vccz LW_52
    s_branch L_MXD
L_PW:
LW_53:
    ds_read_b32 v5, v3 offset:16
    ds_read_b128 v[208:211], v17 offset:0
    ds_read_b128 v[212:215], v17 offset:32
    ds_read_b128 v[216:219], v18 offset:0
    ds_read_b128 v[220:223], v18 offset:32
    ds_read_b128 v[224:227], v15 offset:0
    ds_read_b128 v[228:231], v15 offset:32
    s_sub_u32 s70, s70, 1
    s_cbranch_scc1 L_EXIT
    s_waitcnt lgkmcnt(0)
    v_cmp_le_u32 vcc, 4, v5
    s_cbranch_vccz LW_53
    s_branch L_PWD
L_C3:
LW_54:
    ds_read_b32 v5, v3 offset:208
    s_sub_u32 s70, s70, 1
    s_cbranch_scc1 L_EXIT
    s_waitcnt lgkmcnt(0)
    v_cmp_le_u32 vcc, 2, v5
    s_cbranch_vccz LW_54
    ds_read_b128 v[72:75], v20
    ds_read_b128 v[76:79], v21
    ds_read_b128 v[80:83], v22
    ds_read_b128 v[84:87], v23
    ds_read_b128 v[88:91], v24
    ds_read_b128 v[92:95], v25
    ds_read_b128 v[96:99], v26
    ds_read_b128 v[100:103], v27
    s_waitcnt lgkmcnt(0)
    s_branch L_C3D
L_GR:
    v_and_b32_dpp v168, v168, v168 quad_perm:[1,0,3,2] row_mask:0xf bank_mask:0xf
    v_and_b32_dpp v169, v169, v169 quad_perm:[1,0,3,2] row_mask:0xf bank_mask:0xf
    v_and_b32_dpp v170, v170, v170 quad_perm:[1,0,3,2] row_mask:0xf bank_mask:0xf
    v_and_b32_dpp v171, v171, v171 quad_perm:[1,0,3,2] row_mask:0xf bank_mask:0xf
    v_and_b32_dpp v172, v172, v172 quad_perm:[1,0,3,2] row_mask:0xf bank_mask:0xf
    v_and_b32_dpp v173, v173, v173 quad_perm:[1,0,3,2] row_mask:0xf bank_mask:0xf
    v_and_b32_dpp v174, v174, v174 quad_perm:[1,0,3,2] row_mask:0xf bank_mask:0xf
    v_and_b32_dpp v175, v175, v175 quad_perm:[1,0,3,2] row_mask:0xf bank_mask:0xf
    v_and_b32_dpp v168, v168, v168 quad_perm:[2,3,0,1] row_mask:0xf bank_mask:0xf
    v_and_b32_dpp v169, v169, v169 quad_perm:[2,3,0,1] row_mask:0xf bank_mask:0xf
    v_and_b32_dpp v170, v170, v170 quad_perm:[2,3,0,1] row_mask:0xf bank_mask:0xf
    v_and_b32_dpp v171, v171, v171 quad_perm:[2,3,0,1] row_mask:0xf bank_mask:0xf
    v_and_b32_dpp v172, v172, v172 quad_perm:[2,3,0,1] row_mask:0xf bank_mask:0xf
    v_and_b32_dpp v173, v173, v173 quad_perm:[2,3,0,1] row_mask:0xf bank_mask:0xf
    v_and_b32_dpp v174, v174, v174 quad_perm:[2,3,0,1] row_mask:0xf bank_mask:0xf
    v_and_b32_dpp v175, v175, v175 quad_perm:[2,3,0,1] row_mask:0xf bank_mask:0xf
    v_and_b32_dpp v168, v168, v168 row_half_mirror row_mask:0xf bank_mask:0xf
    v_and_b32_dpp v169, v169, v169 row_half_mirror row_mask:0xf bank_mask:0xf
    v_and_b32_dpp v170, v170, v170 row_half_mirror row_mask:0xf bank_mask:0xf
    v_and_b32_dpp v171, v171, v171 row_half_mirror row_mask:0xf bank_mask:0xf
    v_and_b32_dpp v172, v172, v172 row_half_mirror row_mask:0xf bank_mask:0xf
    v_and_b32_dpp v173, v173, v173 row_half_mirror row_mask:0xf bank_mask:0xf
    v_and_b32_dpp v174, v174, v174 row_half_mirror row_mask:0xf bank_mask:0xf
    v_and_b32_dpp v175, v175, v175 row_half_mirror row_mask:0xf bank_mask:0xf
    v_cmp_ne_u32 s[52:53], s28, v168
    v_cmp_ne_u32 s[54:55], s28, v169
    v_cmp_ne_u32 s[56:57], s28, v170
    v_cmp_ne_u32 s[58:59], s28, v171
    v_cmp_ne_u32 s[60:61], s28, v172
    v_cmp_ne_u32 s[62:63], s28, v173
    v_cmp_ne_u32 s[64:65], s28, v174
    v_cmp_ne_u32 s[66:67], s28, v175
    s_sleep 2
    s_sub_u32 s70, s70, 1
    s_cbranch_scc1 L_EXIT
    s_mov_b64 exec, s[52:53]
    s_cbranch_execz L_GS0
    global_load_dwordx4 v[136:139], v17, s[42:43] offset:0 sc1
L_GS0:
    s_mov_b64 exec, s[54:55]
    s_cbranch_execz L_GS1
    global_load_dwordx4 v[140:143], v17, s[42:43] offset:1024 sc1
L_GS1:
    s_mov_b64 exec, s[56:57]
    s_cbranch_execz L_GS2
    global_load_dwordx4 v[144:147], v17, s[42:43] offset:2048 sc1
L_GS2:
    s_mov_b64 exec, s[58:59]
    s_cbranch_execz L_GS3
    global_load_dwordx4 v[148:151], v17, s[42:43] offset:3072 sc1
L_GS3:
    s_mov_b64 exec, s[60:61]
    s_cbranch_execz L_GS4
    global_load_dwordx4 v[152:155], v18, s[42:43] offset:0 sc1
L_GS4:
    s_mov_b64 exec, s[62:63]
    s_cbranch_execz L_GS5
    global_load_dwordx4 v[156:159], v18, s[42:43] offset:1024 sc1
L_GS5:
    s_mov_b64 exec, s[64:65]
    s_cbranch_execz L_GS6
    global_load_dwordx4 v[160:163], v18, s[42:43] offset:2048 sc1
L_GS6:
    s_mov_b64 exec, s[66:67]
    s_cbranch_execz L_GS7
    global_load_dwordx4 v[164:167], v18, s[42:43] offset:3072 sc1
L_GS7:
    s_waitcnt vmcnt(0)
    s_mov_b64 exec, s[52:53]
    v_xor_b32 v136, v136, v8
    v_xor_b32 v137, v137, v9
    v_xor_b32 v138, v138, v10
    v_xor_b32 v139, v139, v11
    ds_write_b128 v38, v[136:139] offset:0
    v_bitop3_b32 v168, v136, v137, v138 bitop3:0x80
    v_bitop3_b32 v168, v168, v139, s28 bitop3:0x80
    s_mov_b64 exec, s[54:55]
    v_xor_b32 v140, v140, v8
    v_xor_b32 v141, v141, v9
    v_xor_b32 v142, v142, v10
    v_xor_b32 v143, v143, v11
    ds_write_b128 v38, v[140:143] offset:8192
    v_bitop3_b32 v169, v140, v141, v142 bitop3:0x80
    v_bitop3_b32 v169, v169, v143, s28 bitop3:0x80
    s_mov_b64 exec, s[56:57]
    v_xor_b32 v144, v144, v8
    v_xor_b32 v145, v145, v9
    v_xor_b32 v146, v146, v10
    v_xor_b32 v147, v147, v11
    ds_write_b128 v38, v[144:147] offset:16384
    v_bitop3_b32 v170, v144, v145, v146 bitop3:0x80
    v_bitop3_b32 v170, v170, v147, s28 bitop3:0x80
    s_mov_b64 exec, s[58:59]
    v_xor_b32 v148, v148, v8
    v_xor_b32 v149, v149, v9
    v_xor_b32 v150, v150, v10
    v_xor_b32 v151, v151, v11
    ds_write_b128 v38, v[148:151] offset:24576
    v_bitop3_b32 v171, v148, v149, v150 bitop3:0x80
    v_bitop3_b32 v171, v171, v151, s28 bitop3:0x80
    s_mov_b64 exec, s[60:61]
    v_xor_b32 v152, v152, v8
    v_xor_b32 v153, v153, v9
    v_xor_b32 v154, v154, v10
    v_xor_b32 v155, v155, v11
    ds_write_b128 v39, v[152:155] offset:0
    v_bitop3_b32 v172, v152, v153, v154 bitop3:0x80
    v_bitop3_b32 v172, v172, v155, s28 bitop3:0x80
    s_mov_b64 exec, s[62:63]
    v_xor_b32 v156, v156, v8
    v_xor_b32 v157, v157, v9
    v_xor_b32 v158, v158, v10
    v_xor_b32 v159, v159, v11
    ds_write_b128 v39, v[156:159] offset:8192
    v_bitop3_b32 v173, v156, v157, v158 bitop3:0x80
    v_bitop3_b32 v173, v173, v159, s28 bitop3:0x80
    s_mov_b64 exec, s[64:65]
    v_xor_b32 v160, v160, v8
    v_xor_b32 v161, v161, v9
    v_xor_b32 v162, v162, v10
    v_xor_b32 v163, v163, v11
    ds_write_b128 v39, v[160:163] offset:16384
    v_bitop3_b32 v174, v160, v161, v162 bitop3:0x80
    v_bitop3_b32 v174, v174, v163, s28 bitop3:0x80
    s_mov_b64 exec, s[66:67]
    v_xor_b32 v164, v164, v8
    v_xor_b32 v165, v165, v9
    v_xor_b32 v166, v166, v10
    v_xor_b32 v167, v167, v11
    ds_write_b128 v39, v[164:167] offset:24576
    v_bitop3_b32 v175, v164, v165, v166 bitop3:0x80
    v_bitop3_b32 v175, v175, v167, s28 bitop3:0x80
    s_mov_b64 exec, -1
    v_bitop3_b32 v5, v168, v169, v170 bitop3:0x80
    v_bitop3_b32 v5, v5, v171, v172 bitop3:0x80
    v_bitop3_b32 v5, v5, v173, v174 bitop3:0x80
    v_bitop3_b32 v5, v5, v175, s28 bitop3:0x80
    v_cmp_ne_u32 vcc, s28, v5
    s_cbranch_vccnz L_GR
    s_branch L_GD
L_A4:
    s_lshl_b32 s8, s7, 9
    s_add_u32 s8, s8, 196608
    v_lshl_add_u32 v17, v12, 4, s8
    v_lshl_add_u32 v18, v12, 5, v3
    v_add_u32 v18, -1280, v18
    v_mov_b32 v22, s40
    v_not_b32 v23, v22
    v_mov_b32 v28, -1
    v_mov_b32 v29, -1
    v_mov_b32 v30, -1
    v_mov_b32 v31, -1
    s_mul_i32 s8, s7, 2560
    s_add_u32 s8, s8, 458752
    v_lshl_add_u32 v24, v0, 4, s8
    v_lshl_add_u32 v25, v0, 3, s8
    s_and_b32 s8, s2, 63
    s_mul_i32 s8, s8, 67712
    s_add_u32 s12, s8, 8454144
    v_lshl_add_u32 v7, v0, 2, v3
    s_mov_b32 s8, s40
    s_mov_b32 s9, s40
LW_55:
    ds_read_b32 v5, v3 offset:196
    s_sub_u32 s70, s70, 1
    s_cbranch_scc1 L_EXIT
    s_waitcnt lgkmcnt(0)
    v_cmp_le_u32 vcc, 2, v5
    s_cbranch_vccnz LK_56
    s_sleep 4
    s_branch LW_55
LK_56:
    s_sleep 4
    s_setprio 3
L_GO4:
    s_load_dwordx8 s[20:27], s[42:43], s12 glc
    s_sub_u32 s70, s70, 1
    s_cbranch_scc1 L_EXIT
    s_waitcnt lgkmcnt(0)
    s_mov_b32 s10, 0
    s_cmp_eq_u64 s[20:21], s[8:9]
    s_cselect_b32 s11, 1, 0
    s_or_b32 s10, s10, s11
    s_cmp_eq_u64 s[22:23], s[8:9]
    s_cselect_b32 s11, 2, 0
    s_or_b32 s10, s10, s11
    s_cmp_eq_u64 s[24:25], s[8:9]
    s_cselect_b32 s11, 4, 0
    s_or_b32 s10, s10, s11
    s_cmp_eq_u64 s[26:27], s[8:9]
    s_cselect_b32 s11, 8, 0
    s_or_b32 s10, s10, s11
    s_cbranch_scc0 L_GO4
    s_mov_b32 exec_lo, s10
    s_mov_b32 exec_hi, 0
    ds_write_b32 v7, v4 offset:224
    s_cmp_eq_u32 s10, 15
    s_cbranch_scc0 L_GO4
    s_mov_b64 exec, -1
    s_setprio 0
LW_57:
    ds_read_b32 v5, v3 offset:4
    s_sub_u32 s70, s70, 1
    s_cbranch_scc1 L_EXIT
    s_waitcnt lgkmcnt(0)
    v_cmp_le_u32 vcc, 4, v5
    s_cbranch_vccnz LK_58
    s_sleep 4
    s_branch LW_57
LK_58:
    global_store_dwordx4 v24, v[28:31], s[42:43] sc1
    global_store_dwordx4 v24, v[28:31], s[42:43] offset:1024 sc1
    global_store_dwordx2 v25, v[28:29], s[42:43] offset:2048 sc1
LW_59:
    ds_read_b32 v5, v3 offset:12
    s_sub_u32 s70, s70, 1
    s_cbranch_scc1 L_EXIT
    s_waitcnt lgkmcnt(0)
    v_cmp_le_u32 vcc, 6, v5
    s_cbranch_vccnz LK_60
    s_sleep 2
    s_branch LW_59
LK_60:
    s_waitcnt vmcnt(0)
    s_setprio 3
LW_61:
    ds_read_b32 v5, v3 offset:56
    ds_read_b128 v[40:43], v18
    ds_read_b128 v[44:47], v18 offset:16
    ds_read_b32 v20, v16 offset:64
    s_sub_u32 s70, s70, 1
    s_cbranch_scc1 L_EXIT
    s_waitcnt lgkmcnt(0)
    v_cmp_le_u32 vcc, 4, v5
    s_cbranch_vccz LW_61
    v_pk_add_f32 v[40:41], v[40:41], v[42:43]
    v_pk_add_f32 v[44:45], v[44:45], v[46:47]
    v_pk_add_f32 v[40:41], v[40:41], v[44:45]
    v_add_f32 v21, v40, v41
    s_mov_b32 exec_hi, 0
    global_store_dwordx4 v17, v[20:23], s[42:43] sc1
    s_mov_b64 exec, -1
    s_setprio 0
    s_cmp_lt_u32 s15, 40
    s_cbranch_scc0 L_EXIT
    v_lshrrev_b32 v5, 2, v0
    v_and_b32 v6, 3, v0
    s_lshr_b32 s8, s15, 2
    s_lshl_b32 s8, s8, 10
    s_and_b32 s9, s15, 3
    s_lshl_b32 s9, s9, 5
    s_add_u32 s8, s8, s9
    s_add_u32 s8, s8, 457984
    v_lshlrev_b32 v7, 7, v5
    v_lshl_add_u32 v7, v6, 3, v7
    v_add_u32 v12, s8, v7
    s_lshl_b32 s13, s15, 5
    v_lshl_add_u32 v13, v6, 3, s13
    s_lshr_b32 s12, s15, 1
    s_mul_i32 s8, s12, 54*128
    s_and_b32 s9, s15, 1
    s_lshl_b32 s9, s9, 6
    s_add_u32 s8, s8, s9
    s_add_u32 s52, s8, 499712
    s_add_u32 s53, s52, 138240
    v_lshlrev_b32 v16, 7, v5
    v_lshl_add_u32 v16, v6, 4, v16
    v_add_u32 v17, 4096, v16
    v_and_b32 v7, 1, v2
    v_lshlrev_b32 v7, 2, v7
    v_and_b32 v14, 2, v2
    v_add3_u32 v14, v7, v14, v13
    v_mov_b32 v60, 0
    v_mov_b32 v76, 0
    v_mov_b32 v61, 0
    v_mov_b32 v77, 0
    v_mov_b32 v62, 0
    v_mov_b32 v78, 0
    v_mov_b32 v63, 0
    v_mov_b32 v79, 0
    v_mov_b32 v44, 0
    v_mov_b32 v45, 0
LW_62:
    ds_read_b32 v5, v3 offset:32
    s_sub_u32 s70, s70, 1
    s_cbranch_scc1 L_EXIT
    s_waitcnt lgkmcnt(0)
    v_cmp_le_u32 vcc, 4, v5
    s_cbranch_vccnz LK_63
    s_sleep 4
    s_branch LW_62
LK_63:
    s_mov_b32 s8, 0
    s_mov_b32 s9, 0x0f000000
    s_mov_b64 exec, s[8:9]
    global_load_dwordx2 v[44:45], v13, s[16:17]
    s_mov_b32 s9, 0xf0000000
    s_mov_b64 exec, s[8:9]
    global_load_dwordx2 v[44:45], v13, s[36:37]
    s_mov_b64 exec, -1
LW_64:
    ds_read_b32 v5, v3 offset:36
    s_sub_u32 s70, s70, 1
    s_cbranch_scc1 L_EXIT
    s_waitcnt lgkmcnt(0)
    v_cmp_le_u32 vcc, 4, v5
    s_cbranch_vccnz LK_65
    s_sleep 1
    s_branch LW_64
LK_65:
    s_mov_b32 s8, 0xff000000
    s_mov_b32 s9, 0x00ffffff
    s_mov_b64 exec, s[8:9]
    s_branch VP_66
VR_67:
    s_sleep 1
VP_66:
    global_load_dwordx2 v[44:45], v12, s[42:43] sc1
    s_sub_u32 s70, s70, 1
    s_cbranch_scc1 L_EXIT
VF_68:
    s_waitcnt vmcnt(0)
    v_max_u32 v5, v44, v45
    v_cmp_eq_u32 vcc, -1, v5
    s_cbranch_vccnz VR_67
    s_mov_b64 exec, -1
    v_lshlrev_b32 v80, 16, v44
    v_and_b32 v81, 0xffff0000, v44
    v_lshlrev_b32 v82, 16, v45
    v_and_b32 v83, 0xffff0000, v45
    s_sleep 11
    buffer_load_dwordx4 v[48:51], v16, s[44:47], s52 offen sc1
    buffer_load_dwordx4 v[52:55], v16, s[44:47], s52 offen offset:2048 sc1
    buffer_load_dwordx4 v[56:59], v17, s[44:47], s52 offen sc1
    s_mov_b64 exec, 0xffffff
    buffer_load_dwordx4 v[60:63], v17, s[44:47], s52 offen offset:2048 sc1
    s_mov_b64 exec, -1
    s_sleep 4
V2_69:
    buffer_load_dwordx4 v[64:67], v16, s[44:47], s53 offen sc1
    buffer_load_dwordx4 v[68:71], v16, s[44:47], s53 offen offset:2048 sc1
    buffer_load_dwordx4 v[72:75], v17, s[44:47], s53 offen sc1
    s_mov_b64 exec, 0xffffff
    buffer_load_dwordx4 v[76:79], v17, s[44:47], s53 offen offset:2048 sc1
    s_mov_b64 exec, -1
    s_sub_u32 s70, s70, 1
    s_cbranch_scc1 L_EXIT
    s_waitcnt vmcnt(4)
    v_add_f32 v40, v48, v80
    v_add_f32 v84, v52, v56
    v_add_f32 v41, v49, v81
    v_add_f32 v85, v53, v57
    v_add_f32 v42, v50, v82
    v_add_f32 v86, v54, v58
    v_add_f32 v43, v51, v83
    v_add_f32 v87, v55, v59
    v_add_f32 v40, v40, v60
    v_add_f32 v41, v41, v61
    v_add_f32 v42, v42, v62
    v_add_f32 v43, v43, v63
    v_max3_u32 v5, v48, v49, v50
    v_max3_u32 v5, v5, v51, v52
    v_max3_u32 v5, v5, v53, v54
    v_max3_u32 v5, v5, v55, v56
    v_max3_u32 v5, v5, v57, v58
    v_max3_u32 v5, v5, v59, v60
    v_max3_u32 v5, v5, v61, v62
    v_max_u32 v5, v5, v63
    v_cmp_eq_u32 vcc, -1, v5
    s_cbranch_vccz VD_70
    buffer_load_dwordx4 v[48:51], v16, s[44:47], s52 offen sc1
    buffer_load_dwordx4 v[52:55], v16, s[44:47], s52 offen offset:2048 sc1
    buffer_load_dwordx4 v[56:59], v17, s[44:47], s52 offen sc1
    s_mov_b64 exec, 0xffffff
    buffer_load_dwordx4 v[60:63], v17, s[44:47], s52 offen offset:2048 sc1
    s_mov_b64 exec, -1
    s_waitcnt vmcnt(4)
    v_add_f32 v40, v64, v80
    v_add_f32 v84, v68, v72
    v_add_f32 v41, v65, v81
    v_add_f32 v85, v69, v73
    v_add_f32 v42, v66, v82
    v_add_f32 v86, v70, v74
    v_add_f32 v43, v67, v83
    v_add_f32 v87, v71, v75
    v_add_f32 v40, v40, v76
    v_add_f32 v41, v41, v77
    v_add_f32 v42, v42, v78
    v_add_f32 v43, v43, v79
    v_max3_u32 v5, v64, v65, v66
    v_max3_u32 v5, v5, v67, v68
    v_max3_u32 v5, v5, v69, v70
    v_max3_u32 v5, v5, v71, v72
    v_max3_u32 v5, v5, v73, v74
    v_max3_u32 v5, v5, v75, v76
    v_max3_u32 v5, v5, v77, v78
    v_max_u32 v5, v5, v79
    v_cmp_eq_u32 vcc, -1, v5
    s_cbranch_vccnz V2_69
VD_70:
    v_add_f32 v40, v40, v84
    v_add_f32 v41, v41, v85
    v_add_f32 v42, v42, v86
    v_add_f32 v43, v43, v87
    v_permlane32_swap_b32 v40, v41
    s_nop 0
    v_permlane32_swap_b32 v42, v43
    v_add_f32 v40, v40, v41
    v_add_f32 v42, v42, v43
    s_nop 1
    v_permlane16_swap_b32 v40, v42
    v_add_f32 v40, v40, v42
    s_nop 1
    v_add_f32_dpp v40, v40, v40 row_ror:8 row_mask:0xf bank_mask:0xf
    s_nop 1
    v_add_f32_dpp v40, v40, v40 row_ror:4 row_mask:0xf bank_mask:0xf
    v_cvt_pk_bf16_f32 v40, v40, v40
    s_mov_b32 s8, 0x000f000f
    s_mov_b32 s9, 0x000f000f
    s_mov_b64 exec, s[8:9]
    global_store_short v14, v40, s[38:39]
L_EXIT:
L_END:
    s_endpgm
L_CODE_END:

.section .rodata,"a"
.p2align 6
.amdhsa_kernel sequential_preLN__compressed_kv_cla__dense_activation_squared_relu__decode_kernel
  .amdhsa_next_free_vgpr 256
  .amdhsa_next_free_sgpr 102
  .amdhsa_accum_offset 256
  .amdhsa_group_segment_fixed_size 0
  .amdhsa_kernarg_size 112
  .amdhsa_user_sgpr_count 2
  .amdhsa_user_sgpr_kernarg_segment_ptr 1
  .amdhsa_system_sgpr_workgroup_id_x 1
.end_amdhsa_kernel
```
